```python
import torch

def _softmax(x, axis=-1):
    return torch.softmax(x, dim=axis)
def _gelu(x):
    return torch.nn.functional.gelu(x, approximate="tanh")
def _silu(x):
    return torch.nn.functional.silu(x)
def _sigmoid(x):
    return torch.sigmoid(x)
def _layernorm(x, axis=-1, eps=1e-5):
    m = x.mean(dim=axis, keepdim=True)
    v = x.var(dim=axis, keepdim=True, unbiased=False)
    return (x - m) / torch.sqrt(v + eps)
def _scatter_add(tgt, idx, src, axis=0):
    return tgt.clone().index_add_(axis, idx, src)
def _segment_sum(src, seg, n):
    out = torch.zeros((n,) + src.shape[1:], dtype=src.dtype)
    return out.index_add_(0, seg, src)
def _pad(x, pw):
    flat = tuple(v for pair in reversed(pw) for v in pair)
    return torch.nn.functional.pad(x, flat)

kernel_name = 'interleave_layers__ssm_conv_h3__swiglu_ffn__prompt'

def setup_inputs():

    _w = (lambda a: (lambda t: t.to(torch.bfloat16) if t.is_floating_point() else t)(torch.as_tensor(a)))
    def _A_setup():
        B, S, D = 1, 2048, 512
        ks = 4
        return {
            "q": _w((lambda *s: torch.randn(*s, dtype=torch.bfloat16) * 0.05)(B, S, D)),
            "k": _w((lambda *s: torch.randn(*s, dtype=torch.bfloat16) * 0.8)(B, S, D)),
            "v": _w((lambda *s: torch.randn(*s, dtype=torch.bfloat16) * 0.8)(B, S, D)),
            "shift_k": _w((lambda *s: torch.randn(*s, dtype=torch.bfloat16) * 0.8)(D, ks) * 0.5),
            "ssm_k": _w((lambda *s: torch.randn(*s, dtype=torch.bfloat16) * 0.8)(D, S) * (1.0 / S ** 0.5)),
            "ssm_D": _w((lambda *s: torch.randn(*s, dtype=torch.bfloat16) * 0.8)(D)),
        }
    _A_in = _A_setup()

    def _B_setup():
        B, S, D, F = 1, 2048, 512, 1376
        return {
            "x": _w((lambda *s: torch.randn(*s, dtype=torch.bfloat16) * 0.05)(B, S, D)),
            "w_gate": _w((lambda *s: torch.randn(*s, dtype=torch.bfloat16) * 0.1)(D, F)),
            "w_up": _w((lambda *s: torch.randn(*s, dtype=torch.bfloat16) * 0.1)(D, F)),
            "w_down": _w((lambda *s: torch.randn(*s, dtype=torch.bfloat16) * 0.1)(F, D)),
        }
    _B_in = _B_setup()

    return {
        "A_q": _A_in["q"],
        "A_k": _A_in["k"],
        "A_v": _A_in["v"],
        "A_shift_k": _A_in["shift_k"],
        "A_ssm_k": _A_in["ssm_k"],
        "A_ssm_D": _A_in["ssm_D"],
        "B_x": _B_in["x"],
        "B_w_gate": _B_in["w_gate"],
        "B_w_up": _B_in["w_up"],
        "B_w_down": _B_in["w_down"],
    }

def reference(A_q, A_k, A_v, A_shift_k, A_ssm_k, A_ssm_D, B_x, B_w_gate, B_w_up, B_w_down):
    def _A_ref(q, k, v, shift_k, ssm_k, ssm_D):
        B, S, D = q.shape
        ks = shift_k.shape[-1]
        k_pad = _pad(k, ((0, 0), (ks - 1, 0), (0, 0)))
        k_shift = torch.zeros_like(k)
        for t in range(ks):
            k_shift = k_shift + k_pad[:, t:t + S, :] * shift_k[:, ks - 1 - t][None, None, :]
        kv = k_shift * v
        L = 2 * S
        kv_pad = _pad(kv, ((0, 0), (0, S), (0, 0)))
        kf_pad = _pad(ssm_k, ((0, 0), (0, S)))
        kv_f = (lambda x, axes=(-2,-1): torch.fft.rfft2(x.float(), dim=axes))(kv_pad[:, None, :, :], axes=(1, 2))
        kf_f = (lambda x, axes=(-2,-1): torch.fft.rfft2(x.float(), dim=axes))(kf_pad[:, None, :], axes=(1, 2))
        kf_f = (lambda x, *d: x.permute(*d))(kf_f, 1, 2, 0)
        y_f = kv_f * kf_f[None, :, :, :]
        y = (lambda x, s, axes=(-2,-1): torch.fft.irfft2(x, s=s, dim=axes).to(torch.bfloat16))(y_f, (1, L), axes=(1, 2))[:, 0, :S, :]
        y = y + kv * ssm_D[None, None, :]
        return q * y

    def _B_ref(x, w_gate, w_up, w_down):
        g = _silu(x @ w_gate)
        u = x @ w_up
        return (g * u) @ w_down

    x = A_q
    x = x + _A_ref(_layernorm(x, axis=-1), A_k, A_v, A_shift_k, A_ssm_k, A_ssm_D)
    x = x + _B_ref(_layernorm(x, axis=-1), B_w_gate, B_w_up, B_w_down)
    x = x + _A_ref(_layernorm(x, axis=-1), A_k, A_v, A_shift_k, A_ssm_k, A_ssm_D)
    x = x + _B_ref(_layernorm(x, axis=-1), B_w_gate, B_w_up, B_w_down)
    return x
```

```asm
; @launch kernel=conv_kernel grid=(256,1,1) block=(256,1,1) lds=86016
; @launch kernel=ln1_kernel grid=(1288,1,1) block=(256,1,1) lds=8192
; @launch kernel=g1_kernel grid=(352,1,1) block=(256,1,1) lds=65536
; @launch kernel=g2a_kernel grid=(256,1,1) block=(256,1,1) lds=0
; @launch kernel=ln2_kernel grid=(256,1,1) block=(256,1,1) lds=8192
; @launch kernel=g1_kernel grid=(352,1,1) block=(256,1,1) lds=65536
; @launch kernel=g2b_kernel grid=(256,1,1) block=(256,1,1) lds=0
.amdgcn_target "amdgcn-amd-amdhsa--gfx950"
.text
.globl conv_kernel
.p2align 8
.type conv_kernel,@function
conv_kernel:
    s_load_dwordx4 s[40:43], s[0:1], 8
    s_load_dwordx4 s[44:47], s[0:1], 24
    s_load_dwordx2 s[48:49], s[0:1], 40
    s_load_dwordx4 s[52:55], s[0:1], 56
    s_load_dwordx2 s[56:57], s[0:1], 72
    s_load_dwordx2 s[58:59], s[0:1], 96
    v_and_b32 v1, 63, v0
    v_lshrrev_b32 v2, 6, v0
    s_waitcnt lgkmcnt(0)
    s_cmp_ge_u32 s2, 256
    s_cbranch_scc1 L_pk_end
    s_mov_b32 s4, s40
    s_mov_b32 s5, s41
    s_mov_b32 s6, 2097152
    s_mov_b32 s7, 0x00020000
    s_mov_b32 s8, s42
    s_mov_b32 s9, s43
    s_mov_b32 s10, 2097152
    s_mov_b32 s11, 0x00020000
    s_mov_b32 s12, s46
    s_mov_b32 s13, s47
    s_mov_b32 s14, 2097152
    s_mov_b32 s15, 0x00020000
    s_mov_b32 s16, s58
    s_mov_b32 s17, s59
    s_mov_b32 s18, 2097152
    s_mov_b32 s19, 0x00020000
    s_lshl_b32 s60, s2, 4
    s_add_u32 s44, s44, s60
    s_addc_u32 s45, s45, 0
    s_load_dwordx4 s[64:67], s[44:45], 0
    s_lshl_b32 s60, s2, 2
    s_add_u32 s48, s48, s60
    s_addc_u32 s49, s49, 0
    s_load_dword s68, s[48:49], 0
    v_lshlrev_b32 v3, 4, v0
    v_mov_b32 v4, 0
    v_mov_b32 v5, 0
    v_mov_b32 v6, 0
    v_mov_b32 v7, 0
    v_add_u32 v8, 0x10000, v3
    ds_write_b128 v3, v[4:7] offset:0
    ds_write_b128 v3, v[4:7] offset:4096
    ds_write_b128 v3, v[4:7] offset:8192
    ds_write_b128 v3, v[4:7] offset:12288
    ds_write_b128 v3, v[4:7] offset:16384
    ds_write_b128 v3, v[4:7] offset:20480
    ds_write_b128 v3, v[4:7] offset:24576
    ds_write_b128 v3, v[4:7] offset:28672
    ds_write_b128 v3, v[4:7] offset:32768
    ds_write_b128 v3, v[4:7] offset:36864
    ds_write_b128 v3, v[4:7] offset:40960
    ds_write_b128 v3, v[4:7] offset:45056
    ds_write_b128 v3, v[4:7] offset:49152
    ds_write_b128 v3, v[4:7] offset:53248
    ds_write_b128 v3, v[4:7] offset:57344
    ds_write_b128 v3, v[4:7] offset:61440
    ds_write_b128 v8, v[4:7] offset:0
    ds_write_b128 v8, v[4:7] offset:4096
    ds_write_b128 v8, v[4:7] offset:8192
    ds_write_b128 v8, v[4:7] offset:12288
    ds_write_b128 v8, v[4:7] offset:16384
    s_lshl_b32 s60, s2, 2
    v_lshlrev_b32 v3, 13, v0
    v_add_u32 v3, s60, v3
    v_add_u32 v4, 0x1000, v3
    v_subrev_u32 v5, 0xc00, v3
    buffer_load_dword v10, v5, s[4:7], 0 offen offset:0
    buffer_load_dword v11, v5, s[4:7], 0 offen offset:1024
    buffer_load_dword v12, v5, s[4:7], 0 offen offset:2048
    buffer_load_dword v13, v3, s[4:7], 0 offen offset:0
    buffer_load_dword v14, v3, s[4:7], 0 offen offset:1024
    buffer_load_dword v15, v3, s[4:7], 0 offen offset:2048
    buffer_load_dword v16, v3, s[4:7], 0 offen offset:3072
    buffer_load_dword v17, v4, s[4:7], 0 offen offset:0
    buffer_load_dword v18, v4, s[4:7], 0 offen offset:1024
    buffer_load_dword v19, v4, s[4:7], 0 offen offset:2048
    buffer_load_dword v20, v4, s[4:7], 0 offen offset:3072
    buffer_load_dword v24, v3, s[8:11], 0 offen offset:0
    buffer_load_dword v25, v3, s[8:11], 0 offen offset:1024
    buffer_load_dword v26, v3, s[8:11], 0 offen offset:2048
    buffer_load_dword v27, v3, s[8:11], 0 offen offset:3072
    buffer_load_dword v28, v4, s[8:11], 0 offen offset:0
    buffer_load_dword v29, v4, s[8:11], 0 offen offset:1024
    buffer_load_dword v30, v4, s[8:11], 0 offen offset:2048
    buffer_load_dword v31, v4, s[8:11], 0 offen offset:3072
    v_lshrrev_b32 v6, 1, v2
    s_lshl_b32 s61, s2, 1
    v_add_u32 v6, s61, v6
    v_lshlrev_b32 v6, 12, v6
    v_lshl_add_u32 v6, v1, 6, v6
    buffer_load_dwordx4 v[32:35], v6, s[12:15], 0 offen offset:0
    buffer_load_dwordx4 v[36:39], v6, s[12:15], 0 offen offset:16
    buffer_load_dwordx4 v[40:43], v6, s[12:15], 0 offen offset:32
    buffer_load_dwordx4 v[44:47], v6, s[12:15], 0 offen offset:48
    v_subrev_u32 v7, 4, v6
    buffer_load_dword v48, v7, s[12:15], 0 offen
    s_waitcnt lgkmcnt(0)
    s_lshl_b32 s70, s64, 16
    s_and_b32 s71, s64, 0xffff0000
    s_lshl_b32 s72, s65, 16
    s_and_b32 s73, s65, 0xffff0000
    s_lshl_b32 s74, s66, 16
    s_and_b32 s75, s66, 0xffff0000
    s_lshl_b32 s76, s67, 16
    s_and_b32 s77, s67, 0xffff0000
    s_lshl_b32 s78, s68, 16
    s_and_b32 s79, s68, 0xffff0000
    s_mov_b32 s80, 0x05040100
    s_mov_b32 s81, 0x07060302
    s_mov_b32 s82, 0xffff
    s_barrier
    s_waitcnt vmcnt(5)
    v_lshlrev_b32 v52, 16, v10
    v_and_b32 v64, 0xffff0000, v10
    v_lshlrev_b32 v53, 16, v11
    v_and_b32 v65, 0xffff0000, v11
    v_lshlrev_b32 v54, 16, v12
    v_and_b32 v66, 0xffff0000, v12
    v_lshlrev_b32 v55, 16, v13
    v_and_b32 v67, 0xffff0000, v13
    v_lshlrev_b32 v56, 16, v14
    v_and_b32 v68, 0xffff0000, v14
    v_lshlrev_b32 v57, 16, v15
    v_and_b32 v69, 0xffff0000, v15
    v_lshlrev_b32 v58, 16, v16
    v_and_b32 v70, 0xffff0000, v16
    v_lshlrev_b32 v59, 16, v17
    v_and_b32 v71, 0xffff0000, v17
    v_lshlrev_b32 v60, 16, v18
    v_and_b32 v72, 0xffff0000, v18
    v_lshlrev_b32 v61, 16, v19
    v_and_b32 v73, 0xffff0000, v19
    v_lshlrev_b32 v62, 16, v20
    v_and_b32 v74, 0xffff0000, v20
    v_mul_f32 v84, s73, v52
    v_mul_f32 v85, s77, v64
    v_cvt_pk_bf16_f32 v86, v84, v85
    v_lshlrev_b32 v88, 16, v86
    v_and_b32 v89, 0xffff0000, v86
    v_mul_f32 v84, s72, v53
    v_mul_f32 v85, s76, v65
    v_cvt_pk_bf16_f32 v86, v84, v85
    v_lshlrev_b32 v84, 16, v86
    v_and_b32 v85, 0xffff0000, v86
    v_add_f32 v88, v88, v84
    v_add_f32 v89, v89, v85
    v_cvt_pk_bf16_f32 v86, v88, v89
    v_lshlrev_b32 v88, 16, v86
    v_and_b32 v89, 0xffff0000, v86
    v_mul_f32 v84, s71, v54
    v_mul_f32 v85, s75, v66
    v_cvt_pk_bf16_f32 v86, v84, v85
    v_lshlrev_b32 v84, 16, v86
    v_and_b32 v85, 0xffff0000, v86
    v_add_f32 v88, v88, v84
    v_add_f32 v89, v89, v85
    v_cvt_pk_bf16_f32 v86, v88, v89
    v_lshlrev_b32 v88, 16, v86
    v_and_b32 v89, 0xffff0000, v86
    v_mul_f32 v84, s70, v55
    v_mul_f32 v85, s74, v67
    v_cvt_pk_bf16_f32 v86, v84, v85
    v_lshlrev_b32 v84, 16, v86
    v_and_b32 v85, 0xffff0000, v86
    v_add_f32 v88, v88, v84
    v_add_f32 v89, v89, v85
    v_cvt_pk_bf16_f32 v86, v88, v89
    v_lshlrev_b32 v88, 16, v86
    v_and_b32 v89, 0xffff0000, v86
    v_lshlrev_b32 v84, 16, v24
    v_and_b32 v85, 0xffff0000, v24
    v_mul_f32 v84, v84, v88
    v_mul_f32 v85, v85, v89
    v_cvt_pk_bf16_f32 v76, v84, v85
    v_mul_f32 v84, s73, v53
    v_mul_f32 v85, s77, v65
    v_cvt_pk_bf16_f32 v86, v84, v85
    v_lshlrev_b32 v88, 16, v86
    v_and_b32 v89, 0xffff0000, v86
    v_mul_f32 v84, s72, v54
    v_mul_f32 v85, s76, v66
    v_cvt_pk_bf16_f32 v86, v84, v85
    v_lshlrev_b32 v84, 16, v86
    v_and_b32 v85, 0xffff0000, v86
    v_add_f32 v88, v88, v84
    v_add_f32 v89, v89, v85
    v_cvt_pk_bf16_f32 v86, v88, v89
    v_lshlrev_b32 v88, 16, v86
    v_and_b32 v89, 0xffff0000, v86
    v_mul_f32 v84, s71, v55
    v_mul_f32 v85, s75, v67
    v_cvt_pk_bf16_f32 v86, v84, v85
    v_lshlrev_b32 v84, 16, v86
    v_and_b32 v85, 0xffff0000, v86
    v_add_f32 v88, v88, v84
    v_add_f32 v89, v89, v85
    v_cvt_pk_bf16_f32 v86, v88, v89
    v_lshlrev_b32 v88, 16, v86
    v_and_b32 v89, 0xffff0000, v86
    v_mul_f32 v84, s70, v56
    v_mul_f32 v85, s74, v68
    v_cvt_pk_bf16_f32 v86, v84, v85
    v_lshlrev_b32 v84, 16, v86
    v_and_b32 v85, 0xffff0000, v86
    v_add_f32 v88, v88, v84
    v_add_f32 v89, v89, v85
    v_cvt_pk_bf16_f32 v86, v88, v89
    v_lshlrev_b32 v88, 16, v86
    v_and_b32 v89, 0xffff0000, v86
    v_lshlrev_b32 v84, 16, v25
    v_and_b32 v85, 0xffff0000, v25
    v_mul_f32 v84, v84, v88
    v_mul_f32 v85, v85, v89
    v_cvt_pk_bf16_f32 v77, v84, v85
    v_mul_f32 v84, s73, v54
    v_mul_f32 v85, s77, v66
    v_cvt_pk_bf16_f32 v86, v84, v85
    v_lshlrev_b32 v88, 16, v86
    v_and_b32 v89, 0xffff0000, v86
    v_mul_f32 v84, s72, v55
    v_mul_f32 v85, s76, v67
    v_cvt_pk_bf16_f32 v86, v84, v85
    v_lshlrev_b32 v84, 16, v86
    v_and_b32 v85, 0xffff0000, v86
    v_add_f32 v88, v88, v84
    v_add_f32 v89, v89, v85
    v_cvt_pk_bf16_f32 v86, v88, v89
    v_lshlrev_b32 v88, 16, v86
    v_and_b32 v89, 0xffff0000, v86
    v_mul_f32 v84, s71, v56
    v_mul_f32 v85, s75, v68
    v_cvt_pk_bf16_f32 v86, v84, v85
    v_lshlrev_b32 v84, 16, v86
    v_and_b32 v85, 0xffff0000, v86
    v_add_f32 v88, v88, v84
    v_add_f32 v89, v89, v85
    v_cvt_pk_bf16_f32 v86, v88, v89
    v_lshlrev_b32 v88, 16, v86
    v_and_b32 v89, 0xffff0000, v86
    v_mul_f32 v84, s70, v57
    v_mul_f32 v85, s74, v69
    v_cvt_pk_bf16_f32 v86, v84, v85
    v_lshlrev_b32 v84, 16, v86
    v_and_b32 v85, 0xffff0000, v86
    v_add_f32 v88, v88, v84
    v_add_f32 v89, v89, v85
    v_cvt_pk_bf16_f32 v86, v88, v89
    v_lshlrev_b32 v88, 16, v86
    v_and_b32 v89, 0xffff0000, v86
    v_lshlrev_b32 v84, 16, v26
    v_and_b32 v85, 0xffff0000, v26
    v_mul_f32 v84, v84, v88
    v_mul_f32 v85, v85, v89
    v_cvt_pk_bf16_f32 v78, v84, v85
    v_mul_f32 v84, s73, v55
    v_mul_f32 v85, s77, v67
    v_cvt_pk_bf16_f32 v86, v84, v85
    v_lshlrev_b32 v88, 16, v86
    v_and_b32 v89, 0xffff0000, v86
    v_mul_f32 v84, s72, v56
    v_mul_f32 v85, s76, v68
    v_cvt_pk_bf16_f32 v86, v84, v85
    v_lshlrev_b32 v84, 16, v86
    v_and_b32 v85, 0xffff0000, v86
    v_add_f32 v88, v88, v84
    v_add_f32 v89, v89, v85
    v_cvt_pk_bf16_f32 v86, v88, v89
    v_lshlrev_b32 v88, 16, v86
    v_and_b32 v89, 0xffff0000, v86
    v_mul_f32 v84, s71, v57
    v_mul_f32 v85, s75, v69
    v_cvt_pk_bf16_f32 v86, v84, v85
    v_lshlrev_b32 v84, 16, v86
    v_and_b32 v85, 0xffff0000, v86
    v_add_f32 v88, v88, v84
    v_add_f32 v89, v89, v85
    v_cvt_pk_bf16_f32 v86, v88, v89
    v_lshlrev_b32 v88, 16, v86
    v_and_b32 v89, 0xffff0000, v86
    v_mul_f32 v84, s70, v58
    v_mul_f32 v85, s74, v70
    v_cvt_pk_bf16_f32 v86, v84, v85
    v_lshlrev_b32 v84, 16, v86
    v_and_b32 v85, 0xffff0000, v86
    v_add_f32 v88, v88, v84
    v_add_f32 v89, v89, v85
    v_cvt_pk_bf16_f32 v86, v88, v89
    v_lshlrev_b32 v88, 16, v86
    v_and_b32 v89, 0xffff0000, v86
    v_lshlrev_b32 v84, 16, v27
    v_and_b32 v85, 0xffff0000, v27
    v_mul_f32 v84, v84, v88
    v_mul_f32 v85, v85, v89
    v_cvt_pk_bf16_f32 v79, v84, v85
    v_mul_f32 v84, s73, v56
    v_mul_f32 v85, s77, v68
    v_cvt_pk_bf16_f32 v86, v84, v85
    v_lshlrev_b32 v88, 16, v86
    v_and_b32 v89, 0xffff0000, v86
    v_mul_f32 v84, s72, v57
    v_mul_f32 v85, s76, v69
    v_cvt_pk_bf16_f32 v86, v84, v85
    v_lshlrev_b32 v84, 16, v86
    v_and_b32 v85, 0xffff0000, v86
    v_add_f32 v88, v88, v84
    v_add_f32 v89, v89, v85
    v_cvt_pk_bf16_f32 v86, v88, v89
    v_lshlrev_b32 v88, 16, v86
    v_and_b32 v89, 0xffff0000, v86
    v_mul_f32 v84, s71, v58
    v_mul_f32 v85, s75, v70
    v_cvt_pk_bf16_f32 v86, v84, v85
    v_lshlrev_b32 v84, 16, v86
    v_and_b32 v85, 0xffff0000, v86
    v_add_f32 v88, v88, v84
    v_add_f32 v89, v89, v85
    v_cvt_pk_bf16_f32 v86, v88, v89
    v_lshlrev_b32 v88, 16, v86
    v_and_b32 v89, 0xffff0000, v86
    v_mul_f32 v84, s70, v59
    v_mul_f32 v85, s74, v71
    v_cvt_pk_bf16_f32 v86, v84, v85
    v_lshlrev_b32 v84, 16, v86
    v_and_b32 v85, 0xffff0000, v86
    v_add_f32 v88, v88, v84
    v_add_f32 v89, v89, v85
    v_cvt_pk_bf16_f32 v86, v88, v89
    v_lshlrev_b32 v88, 16, v86
    v_and_b32 v89, 0xffff0000, v86
    v_lshlrev_b32 v84, 16, v28
    v_and_b32 v85, 0xffff0000, v28
    v_mul_f32 v84, v84, v88
    v_mul_f32 v85, v85, v89
    v_cvt_pk_bf16_f32 v80, v84, v85
    v_mul_f32 v84, s73, v57
    v_mul_f32 v85, s77, v69
    v_cvt_pk_bf16_f32 v86, v84, v85
    v_lshlrev_b32 v88, 16, v86
    v_and_b32 v89, 0xffff0000, v86
    v_mul_f32 v84, s72, v58
    v_mul_f32 v85, s76, v70
    v_cvt_pk_bf16_f32 v86, v84, v85
    v_lshlrev_b32 v84, 16, v86
    v_and_b32 v85, 0xffff0000, v86
    v_add_f32 v88, v88, v84
    v_add_f32 v89, v89, v85
    v_cvt_pk_bf16_f32 v86, v88, v89
    v_lshlrev_b32 v88, 16, v86
    v_and_b32 v89, 0xffff0000, v86
    v_mul_f32 v84, s71, v59
    v_mul_f32 v85, s75, v71
    v_cvt_pk_bf16_f32 v86, v84, v85
    v_lshlrev_b32 v84, 16, v86
    v_and_b32 v85, 0xffff0000, v86
    v_add_f32 v88, v88, v84
    v_add_f32 v89, v89, v85
    v_cvt_pk_bf16_f32 v86, v88, v89
    v_lshlrev_b32 v88, 16, v86
    v_and_b32 v89, 0xffff0000, v86
    v_mul_f32 v84, s70, v60
    v_mul_f32 v85, s74, v72
    v_cvt_pk_bf16_f32 v86, v84, v85
    v_lshlrev_b32 v84, 16, v86
    v_and_b32 v85, 0xffff0000, v86
    v_add_f32 v88, v88, v84
    v_add_f32 v89, v89, v85
    v_cvt_pk_bf16_f32 v86, v88, v89
    v_lshlrev_b32 v88, 16, v86
    v_and_b32 v89, 0xffff0000, v86
    v_lshlrev_b32 v84, 16, v29
    v_and_b32 v85, 0xffff0000, v29
    v_mul_f32 v84, v84, v88
    v_mul_f32 v85, v85, v89
    v_cvt_pk_bf16_f32 v81, v84, v85
    v_mul_f32 v84, s73, v58
    v_mul_f32 v85, s77, v70
    v_cvt_pk_bf16_f32 v86, v84, v85
    v_lshlrev_b32 v88, 16, v86
    v_and_b32 v89, 0xffff0000, v86
    v_mul_f32 v84, s72, v59
    v_mul_f32 v85, s76, v71
    v_cvt_pk_bf16_f32 v86, v84, v85
    v_lshlrev_b32 v84, 16, v86
    v_and_b32 v85, 0xffff0000, v86
    v_add_f32 v88, v88, v84
    v_add_f32 v89, v89, v85
    v_cvt_pk_bf16_f32 v86, v88, v89
    v_lshlrev_b32 v88, 16, v86
    v_and_b32 v89, 0xffff0000, v86
    v_mul_f32 v84, s71, v60
    v_mul_f32 v85, s75, v72
    v_cvt_pk_bf16_f32 v86, v84, v85
    v_lshlrev_b32 v84, 16, v86
    v_and_b32 v85, 0xffff0000, v86
    v_add_f32 v88, v88, v84
    v_add_f32 v89, v89, v85
    v_cvt_pk_bf16_f32 v86, v88, v89
    v_lshlrev_b32 v88, 16, v86
    v_and_b32 v89, 0xffff0000, v86
    v_mul_f32 v84, s70, v61
    v_mul_f32 v85, s74, v73
    v_cvt_pk_bf16_f32 v86, v84, v85
    v_lshlrev_b32 v84, 16, v86
    v_and_b32 v85, 0xffff0000, v86
    v_add_f32 v88, v88, v84
    v_add_f32 v89, v89, v85
    v_cvt_pk_bf16_f32 v86, v88, v89
    v_lshlrev_b32 v88, 16, v86
    v_and_b32 v89, 0xffff0000, v86
    v_lshlrev_b32 v84, 16, v30
    v_and_b32 v85, 0xffff0000, v30
    v_mul_f32 v84, v84, v88
    v_mul_f32 v85, v85, v89
    v_cvt_pk_bf16_f32 v82, v84, v85
    v_mul_f32 v84, s73, v59
    v_mul_f32 v85, s77, v71
    v_cvt_pk_bf16_f32 v86, v84, v85
    v_lshlrev_b32 v88, 16, v86
    v_and_b32 v89, 0xffff0000, v86
    v_mul_f32 v84, s72, v60
    v_mul_f32 v85, s76, v72
    v_cvt_pk_bf16_f32 v86, v84, v85
    v_lshlrev_b32 v84, 16, v86
    v_and_b32 v85, 0xffff0000, v86
    v_add_f32 v88, v88, v84
    v_add_f32 v89, v89, v85
    v_cvt_pk_bf16_f32 v86, v88, v89
    v_lshlrev_b32 v88, 16, v86
    v_and_b32 v89, 0xffff0000, v86
    v_mul_f32 v84, s71, v61
    v_mul_f32 v85, s75, v73
    v_cvt_pk_bf16_f32 v86, v84, v85
    v_lshlrev_b32 v84, 16, v86
    v_and_b32 v85, 0xffff0000, v86
    v_add_f32 v88, v88, v84
    v_add_f32 v89, v89, v85
    v_cvt_pk_bf16_f32 v86, v88, v89
    v_lshlrev_b32 v88, 16, v86
    v_and_b32 v89, 0xffff0000, v86
    v_mul_f32 v84, s70, v62
    v_mul_f32 v85, s74, v74
    v_cvt_pk_bf16_f32 v86, v84, v85
    v_lshlrev_b32 v84, 16, v86
    v_and_b32 v85, 0xffff0000, v86
    v_add_f32 v88, v88, v84
    v_add_f32 v89, v89, v85
    v_cvt_pk_bf16_f32 v86, v88, v89
    v_lshlrev_b32 v88, 16, v86
    v_and_b32 v89, 0xffff0000, v86
    v_lshlrev_b32 v84, 16, v31
    v_and_b32 v85, 0xffff0000, v31
    v_mul_f32 v84, v84, v88
    v_mul_f32 v85, v85, v89
    v_cvt_pk_bf16_f32 v83, v84, v85
    v_lshrrev_b32 v84, 2, v0
    v_add_u32 v84, 32, v84
    v_mul_u32_u24 v84, 80, v84
    v_and_b32 v85, 3, v0
    v_lshl_add_u32 v84, v85, 4, v84
    v_perm_b32 v88, v77, v76, s80
    v_perm_b32 v89, v79, v78, s80
    v_perm_b32 v90, v81, v80, s80
    v_perm_b32 v91, v83, v82, s80
    ds_write_b128 v84, v[88:91] offset:0
    v_perm_b32 v88, v77, v76, s81
    v_perm_b32 v89, v79, v78, s81
    v_perm_b32 v90, v81, v80, s81
    v_perm_b32 v91, v83, v82, s81
    ds_write_b128 v84, v[88:91] offset:7680
    s_waitcnt vmcnt(0)
    v_cmp_eq_u32 vcc, 0, v1
    s_nop 1
    v_cndmask_b32 v48, v48, 0, vcc
    v_lshrrev_b32 v84, 1, v2
    v_mul_u32_u24 v84, 35072, v84
    v_and_b32 v85, 1, v2
    v_mul_u32_u24 v85, 17528, v85
    v_add_u32 v84, v84, v85
    v_lshlrev_b32 v85, 6, v1
    v_sub_u32 v84, v84, v85
    v_add_u32 v84, 15300, v84
    v_alignbit_b32 v92, v32, v32, 16
    v_alignbit_b32 v93, v33, v33, 16
    v_alignbit_b32 v94, v34, v34, 16
    v_alignbit_b32 v95, v35, v35, 16
    v_alignbit_b32 v96, v36, v36, 16
    v_alignbit_b32 v97, v37, v37, 16
    v_alignbit_b32 v98, v38, v38, 16
    v_alignbit_b32 v99, v39, v39, 16
    v_alignbit_b32 v100, v40, v40, 16
    v_alignbit_b32 v101, v41, v41, 16
    v_alignbit_b32 v102, v42, v42, 16
    v_alignbit_b32 v103, v43, v43, 16
    v_alignbit_b32 v104, v44, v44, 16
    v_alignbit_b32 v105, v45, v45, 16
    v_alignbit_b32 v106, v46, v46, 16
    v_alignbit_b32 v107, v47, v47, 16
    v_bfi_b32 v108, s82, v32, v48
    v_bfi_b32 v109, s82, v33, v32
    v_bfi_b32 v110, s82, v34, v33
    v_bfi_b32 v111, s82, v35, v34
    v_bfi_b32 v112, s82, v36, v35
    v_bfi_b32 v113, s82, v37, v36
    v_bfi_b32 v114, s82, v38, v37
    v_bfi_b32 v115, s82, v39, v38
    v_bfi_b32 v116, s82, v40, v39
    v_bfi_b32 v117, s82, v41, v40
    v_bfi_b32 v118, s82, v42, v41
    v_bfi_b32 v119, s82, v43, v42
    v_bfi_b32 v120, s82, v44, v43
    v_bfi_b32 v121, s82, v45, v44
    v_bfi_b32 v122, s82, v46, v45
    v_bfi_b32 v123, s82, v47, v46
    ds_write_b32 v84, v92 offset:4168
    ds_write_b32 v84, v93 offset:4164
    ds_write_b32 v84, v94 offset:4160
    ds_write_b32 v84, v95 offset:4156
    ds_write_b32 v84, v96 offset:4152
    ds_write_b32 v84, v97 offset:4148
    ds_write_b32 v84, v98 offset:4144
    ds_write_b32 v84, v99 offset:4140
    ds_write_b32 v84, v100 offset:4136
    ds_write_b32 v84, v101 offset:4132
    ds_write_b32 v84, v102 offset:4128
    ds_write_b32 v84, v103 offset:4124
    ds_write_b32 v84, v104 offset:4120
    ds_write_b32 v84, v105 offset:4116
    ds_write_b32 v84, v106 offset:4112
    ds_write_b32 v84, v107 offset:4108
    ds_write_b32 v84, v108 offset:8552
    ds_write_b32 v84, v109 offset:8548
    ds_write_b32 v84, v110 offset:8544
    ds_write_b32 v84, v111 offset:8540
    ds_write_b32 v84, v112 offset:8536
    ds_write_b32 v84, v113 offset:8532
    ds_write_b32 v84, v114 offset:8528
    ds_write_b32 v84, v115 offset:8524
    ds_write_b32 v84, v116 offset:8520
    ds_write_b32 v84, v117 offset:8516
    ds_write_b32 v84, v118 offset:8512
    ds_write_b32 v84, v119 offset:8508
    ds_write_b32 v84, v120 offset:8504
    ds_write_b32 v84, v121 offset:8500
    ds_write_b32 v84, v122 offset:8496
    ds_write_b32 v84, v123 offset:8492
    ds_write_b32 v84, v92 offset:12932
    ds_write_b32 v84, v93 offset:12928
    ds_write_b32 v84, v94 offset:12924
    ds_write_b32 v84, v95 offset:12920
    ds_write_b32 v84, v96 offset:12916
    ds_write_b32 v84, v97 offset:12912
    ds_write_b32 v84, v98 offset:12908
    ds_write_b32 v84, v99 offset:12904
    ds_write_b32 v84, v100 offset:12900
    ds_write_b32 v84, v101 offset:12896
    ds_write_b32 v84, v102 offset:12892
    ds_write_b32 v84, v103 offset:12888
    ds_write_b32 v84, v104 offset:12884
    ds_write_b32 v84, v105 offset:12880
    ds_write_b32 v84, v106 offset:12876
    ds_write_b32 v84, v107 offset:12872
    ds_write_b32 v84, v108 offset:17316
    ds_write_b32 v84, v109 offset:17312
    ds_write_b32 v84, v110 offset:17308
    ds_write_b32 v84, v111 offset:17304
    ds_write_b32 v84, v112 offset:17300
    ds_write_b32 v84, v113 offset:17296
    ds_write_b32 v84, v114 offset:17292
    ds_write_b32 v84, v115 offset:17288
    ds_write_b32 v84, v116 offset:17284
    ds_write_b32 v84, v117 offset:17280
    ds_write_b32 v84, v118 offset:17276
    ds_write_b32 v84, v119 offset:17272
    ds_write_b32 v84, v120 offset:17268
    ds_write_b32 v84, v121 offset:17264
    ds_write_b32 v84, v122 offset:17260
    ds_write_b32 v84, v123 offset:17256
    s_waitcnt lgkmcnt(0)
    s_barrier
    v_and_b32 v3, 31, v1
    v_lshrrev_b32 v4, 5, v1
    v_lshrrev_b32 v5, 1, v2
    v_and_b32 v6, 1, v2
    v_sub_u32 v7, 2047, v3
    v_and_b32 v8, 7, v7
    v_sub_u32 v7, v7, v8
    v_lshl_add_u32 v7, v4, 3, v7
    v_lshlrev_b32 v7, 1, v7
    v_mul_u32_u24 v8, 4384, v8
    v_add_u32 v7, v7, v8
    v_mul_u32_u24 v8, 35072, v5
    v_add_u32 v7, v7, v8
    v_add_u32 v7, 15184, v7
    v_lshl_add_u32 v8, v6, 5, v3
    v_mul_u32_u24 v8, 80, v8
    v_lshl_add_u32 v8, v4, 4, v8
    v_mul_u32_u24 v9, 7680, v5
    v_add_u32 v8, v8, v9
    v_add_u32 v9, 2560, v8
    v_add_u32 v8, 2320, v8
    v_readfirstlane_b32 s60, v6
    s_lshl_b32 s60, s60, 3
    s_add_u32 s60, s60, 8
    v_mov_b32 v16, 0
    v_mov_b32 v17, 0
    v_mov_b32 v18, 0
    v_mov_b32 v19, 0
    v_mov_b32 v20, 0
    v_mov_b32 v21, 0
    v_mov_b32 v22, 0
    v_mov_b32 v23, 0
    v_mov_b32 v24, 0
    v_mov_b32 v25, 0
    v_mov_b32 v26, 0
    v_mov_b32 v27, 0
    v_mov_b32 v28, 0
    v_mov_b32 v29, 0
    v_mov_b32 v30, 0
    v_mov_b32 v31, 0
L_cm:
    ds_read_b128 v[40:43], v7 offset:192
    ds_read_b128 v[44:47], v8 offset:240
    ds_read_b128 v[48:51], v7 offset:224
    ds_read_b128 v[52:55], v8 offset:272
    ds_read_b128 v[56:59], v7 offset:128
    ds_read_b128 v[60:63], v8 offset:160
    ds_read_b128 v[64:67], v7 offset:160
    ds_read_b128 v[68:71], v8 offset:192
    ds_read_b128 v[72:75], v7 offset:64
    ds_read_b128 v[76:79], v8 offset:80
    ds_read_b128 v[80:83], v7 offset:96
    ds_read_b128 v[84:87], v8 offset:112
    ds_read_b128 v[88:91], v7 offset:0
    ds_read_b128 v[92:95], v8 offset:0
    ds_read_b128 v[96:99], v7 offset:32
    ds_read_b128 v[100:103], v8 offset:32
    s_waitcnt lgkmcnt(14)
    v_mfma_f32_32x32x16_bf16 v[16:31], v[40:43], v[44:47], v[16:31]
    s_waitcnt lgkmcnt(12)
    v_mfma_f32_32x32x16_bf16 v[16:31], v[48:51], v[52:55], v[16:31]
    s_waitcnt lgkmcnt(10)
    v_mfma_f32_32x32x16_bf16 v[16:31], v[56:59], v[60:63], v[16:31]
    s_waitcnt lgkmcnt(8)
    v_mfma_f32_32x32x16_bf16 v[16:31], v[64:67], v[68:71], v[16:31]
    s_waitcnt lgkmcnt(6)
    v_mfma_f32_32x32x16_bf16 v[16:31], v[72:75], v[76:79], v[16:31]
    s_waitcnt lgkmcnt(4)
    v_mfma_f32_32x32x16_bf16 v[16:31], v[80:83], v[84:87], v[16:31]
    s_waitcnt lgkmcnt(2)
    v_mfma_f32_32x32x16_bf16 v[16:31], v[88:91], v[92:95], v[16:31]
    s_waitcnt lgkmcnt(0)
    v_mfma_f32_32x32x16_bf16 v[16:31], v[96:99], v[100:103], v[16:31]
    v_subrev_u32 v7, 256, v7
    v_subrev_u32 v8, 320, v8
    s_sub_u32 s60, s60, 1
    s_cmp_lg_u32 s60, 0
    s_cbranch_scc1 L_cm
    v_lshlrev_b32 v10, 3, v4
    v_lshlrev_b32 v11, 4, v4
    v_sub_u32 v9, v9, v11
    v_add_u32 v9, v9, v10
    ds_read_b64 v[40:41], v9 offset:0
    ds_read_b64 v[42:43], v9 offset:16
    ds_read_b64 v[44:45], v9 offset:32
    ds_read_b64 v[46:47], v9 offset:48
    v_lshl_add_u32 v10, v6, 5, v3
    v_lshlrev_b32 v10, 5, v10
    v_lshl_add_u32 v10, v4, 2, v10
    v_lshlrev_b32 v10, 1, v10
    s_lshl_b32 s61, s2, 1
    v_add_u32 v11, s61, v5
    v_lshl_add_u32 v10, v11, 12, v10
    v_readfirstlane_b32 s62, v5
    s_nop 3
    s_cmp_eq_u32 s62, 0
    s_cselect_b32 s63, s78, s79
    s_nop 15
    s_waitcnt lgkmcnt(0)
    v_lshlrev_b32 v12, 16, v40
    v_mul_f32 v12, s63, v12
    v_cvt_pk_bf16_f32 v13, v12, v16
    v_lshlrev_b32 v12, 16, v13
    v_and_b32 v13, 0xffff0000, v13
    v_add_f32 v12, v12, v13
    v_cvt_pk_bf16_f32 v32, v12, v12
    v_and_b32 v12, 0xffff0000, v40
    v_mul_f32 v12, s63, v12
    v_cvt_pk_bf16_f32 v13, v12, v17
    v_lshlrev_b32 v12, 16, v13
    v_and_b32 v13, 0xffff0000, v13
    v_add_f32 v12, v12, v13
    v_cvt_pk_bf16_f32 v33, v12, v12
    v_lshlrev_b32 v12, 16, v41
    v_mul_f32 v12, s63, v12
    v_cvt_pk_bf16_f32 v13, v12, v18
    v_lshlrev_b32 v12, 16, v13
    v_and_b32 v13, 0xffff0000, v13
    v_add_f32 v12, v12, v13
    v_cvt_pk_bf16_f32 v34, v12, v12
    v_and_b32 v12, 0xffff0000, v41
    v_mul_f32 v12, s63, v12
    v_cvt_pk_bf16_f32 v13, v12, v19
    v_lshlrev_b32 v12, 16, v13
    v_and_b32 v13, 0xffff0000, v13
    v_add_f32 v12, v12, v13
    v_cvt_pk_bf16_f32 v35, v12, v12
    v_perm_b32 v36, v33, v32, s80
    v_perm_b32 v37, v35, v34, s80
    buffer_store_dwordx2 v[36:37], v10, s[16:19], 0 offen offset:0
    s_nop 1
    v_lshlrev_b32 v12, 16, v42
    v_mul_f32 v12, s63, v12
    v_cvt_pk_bf16_f32 v13, v12, v20
    v_lshlrev_b32 v12, 16, v13
    v_and_b32 v13, 0xffff0000, v13
    v_add_f32 v12, v12, v13
    v_cvt_pk_bf16_f32 v32, v12, v12
    v_and_b32 v12, 0xffff0000, v42
    v_mul_f32 v12, s63, v12
    v_cvt_pk_bf16_f32 v13, v12, v21
    v_lshlrev_b32 v12, 16, v13
    v_and_b32 v13, 0xffff0000, v13
    v_add_f32 v12, v12, v13
    v_cvt_pk_bf16_f32 v33, v12, v12
    v_lshlrev_b32 v12, 16, v43
    v_mul_f32 v12, s63, v12
    v_cvt_pk_bf16_f32 v13, v12, v22
    v_lshlrev_b32 v12, 16, v13
    v_and_b32 v13, 0xffff0000, v13
    v_add_f32 v12, v12, v13
    v_cvt_pk_bf16_f32 v34, v12, v12
    v_and_b32 v12, 0xffff0000, v43
    v_mul_f32 v12, s63, v12
    v_cvt_pk_bf16_f32 v13, v12, v23
    v_lshlrev_b32 v12, 16, v13
    v_and_b32 v13, 0xffff0000, v13
    v_add_f32 v12, v12, v13
    v_cvt_pk_bf16_f32 v35, v12, v12
    v_perm_b32 v36, v33, v32, s80
    v_perm_b32 v37, v35, v34, s80
    buffer_store_dwordx2 v[36:37], v10, s[16:19], 0 offen offset:16
    s_nop 1
    v_lshlrev_b32 v12, 16, v44
    v_mul_f32 v12, s63, v12
    v_cvt_pk_bf16_f32 v13, v12, v24
    v_lshlrev_b32 v12, 16, v13
    v_and_b32 v13, 0xffff0000, v13
    v_add_f32 v12, v12, v13
    v_cvt_pk_bf16_f32 v32, v12, v12
    v_and_b32 v12, 0xffff0000, v44
    v_mul_f32 v12, s63, v12
    v_cvt_pk_bf16_f32 v13, v12, v25
    v_lshlrev_b32 v12, 16, v13
    v_and_b32 v13, 0xffff0000, v13
    v_add_f32 v12, v12, v13
    v_cvt_pk_bf16_f32 v33, v12, v12
    v_lshlrev_b32 v12, 16, v45
    v_mul_f32 v12, s63, v12
    v_cvt_pk_bf16_f32 v13, v12, v26
    v_lshlrev_b32 v12, 16, v13
    v_and_b32 v13, 0xffff0000, v13
    v_add_f32 v12, v12, v13
    v_cvt_pk_bf16_f32 v34, v12, v12
    v_and_b32 v12, 0xffff0000, v45
    v_mul_f32 v12, s63, v12
    v_cvt_pk_bf16_f32 v13, v12, v27
    v_lshlrev_b32 v12, 16, v13
    v_and_b32 v13, 0xffff0000, v13
    v_add_f32 v12, v12, v13
    v_cvt_pk_bf16_f32 v35, v12, v12
    v_perm_b32 v36, v33, v32, s80
    v_perm_b32 v37, v35, v34, s80
    buffer_store_dwordx2 v[36:37], v10, s[16:19], 0 offen offset:32
    s_nop 1
    v_lshlrev_b32 v12, 16, v46
    v_mul_f32 v12, s63, v12
    v_cvt_pk_bf16_f32 v13, v12, v28
    v_lshlrev_b32 v12, 16, v13
    v_and_b32 v13, 0xffff0000, v13
    v_add_f32 v12, v12, v13
    v_cvt_pk_bf16_f32 v32, v12, v12
    v_and_b32 v12, 0xffff0000, v46
    v_mul_f32 v12, s63, v12
    v_cvt_pk_bf16_f32 v13, v12, v29
    v_lshlrev_b32 v12, 16, v13
    v_and_b32 v13, 0xffff0000, v13
    v_add_f32 v12, v12, v13
    v_cvt_pk_bf16_f32 v33, v12, v12
    v_lshlrev_b32 v12, 16, v47
    v_mul_f32 v12, s63, v12
    v_cvt_pk_bf16_f32 v13, v12, v30
    v_lshlrev_b32 v12, 16, v13
    v_and_b32 v13, 0xffff0000, v13
    v_add_f32 v12, v12, v13
    v_cvt_pk_bf16_f32 v34, v12, v12
    v_and_b32 v12, 0xffff0000, v47
    v_mul_f32 v12, s63, v12
    v_cvt_pk_bf16_f32 v13, v12, v31
    v_lshlrev_b32 v12, 16, v13
    v_and_b32 v13, 0xffff0000, v13
    v_add_f32 v12, v12, v13
    v_cvt_pk_bf16_f32 v35, v12, v12
    v_perm_b32 v36, v33, v32, s80
    v_perm_b32 v37, v35, v34, s80
    buffer_store_dwordx2 v[36:37], v10, s[16:19], 0 offen offset:48
    s_nop 1
    s_endpgm
L_pack:
    s_cmp_ge_u32 s2, 1288
    s_cbranch_scc1 L_pk_end
    s_load_dwordx4 s[52:55], s[0:1], 56
    s_load_dwordx2 s[56:57], s[0:1], 72
    s_load_dwordx2 s[58:59], s[0:1], 96
    v_and_b32 v1, 63, v0
    v_lshrrev_b32 v2, 6, v0
    s_waitcnt lgkmcnt(0)
    v_readfirstlane_b32 s60, v2
    s_sub_u32 s61, s2, 256
    s_lshl_b32 s61, s61, 2
    s_add_u32 s61, s61, s60
    v_and_b32 v3, 31, v1
    v_lshrrev_b32 v4, 5, v1
    s_cmp_ge_u32 s61, 2752
    s_cbranch_scc1 L_pk_down
    s_cmp_ge_u32 s61, 1376
    s_cselect_b32 s4, s54, s52
    s_cselect_b32 s5, s55, s53
    s_mov_b32 s6, 1409024
    s_mov_b32 s7, 0x00020000
    s_mov_b32 s62, 4194304
    s_cselect_b32 s62, s62, 2097152
    s_cselect_b32 s63, 1376, 0
    s_sub_u32 s61, s61, s63
    s_lshr_b32 s64, s61, 5
    s_and_b32 s65, s61, 31
    s_lshl_b32 s66, s65, 4
    v_lshl_add_u32 v5, v4, 3, s66
    v_mul_u32_u24 v5, 2752, v5
    s_lshl_b32 s66, s64, 5
    v_add_u32 v6, s66, v3
    v_lshl_add_u32 v5, v6, 1, v5
    buffer_load_ushort v8, v5, s[4:7], 0 offen offset:0
    v_add_u32 v5, 2752, v5
    buffer_load_ushort v9, v5, s[4:7], 0 offen
    v_add_u32 v5, 2752, v5
    buffer_load_ushort v10, v5, s[4:7], 0 offen
    v_add_u32 v5, 2752, v5
    buffer_load_ushort v11, v5, s[4:7], 0 offen
    v_add_u32 v5, 2752, v5
    buffer_load_ushort v12, v5, s[4:7], 0 offen
    v_add_u32 v5, 2752, v5
    buffer_load_ushort v13, v5, s[4:7], 0 offen
    v_add_u32 v5, 2752, v5
    buffer_load_ushort v14, v5, s[4:7], 0 offen
    v_add_u32 v5, 2752, v5
    buffer_load_ushort v15, v5, s[4:7], 0 offen
    v_add_u32 v5, 2752, v5
    s_branch L_pk_st
L_pk_down:
    s_mov_b32 s4, s56
    s_mov_b32 s5, s57
    s_mov_b32 s6, 1409024
    s_mov_b32 s7, 0x00020000
    s_mov_b32 s62, 6291456
    s_sub_u32 s61, s61, 2752
    s_mul_hi_u32 s64, s61, 49941481
    s_mul_i32 s65, s64, 86
    s_sub_u32 s65, s61, s65
    s_lshl_b32 s66, s65, 4
    v_lshl_add_u32 v5, v4, 2, s66
    v_lshlrev_b32 v5, 10, v5
    s_lshl_b32 s66, s64, 5
    v_add_u32 v6, s66, v3
    v_lshl_add_u32 v5, v6, 1, v5
    buffer_load_ushort v8, v5, s[4:7], 0 offen
    v_add_u32 v5, 1024, v5
    buffer_load_ushort v9, v5, s[4:7], 0 offen
    v_add_u32 v5, 1024, v5
    buffer_load_ushort v10, v5, s[4:7], 0 offen
    v_add_u32 v5, 1024, v5
    buffer_load_ushort v11, v5, s[4:7], 0 offen
    v_add_u32 v5, 5120, v5
    buffer_load_ushort v12, v5, s[4:7], 0 offen
    v_add_u32 v5, 1024, v5
    buffer_load_ushort v13, v5, s[4:7], 0 offen
    v_add_u32 v5, 1024, v5
    buffer_load_ushort v14, v5, s[4:7], 0 offen
    v_add_u32 v5, 1024, v5
    buffer_load_ushort v15, v5, s[4:7], 0 offen
    v_add_u32 v5, 1024, v5
L_pk_st:
    s_add_u32 s8, s58, s62
    s_addc_u32 s9, s59, 0
    s_mov_b32 s10, 1409024
    s_mov_b32 s11, 0x00020000
    s_lshl_b32 s61, s61, 10
    v_lshlrev_b32 v5, 4, v1
    v_add_u32 v5, s61, v5
    s_waitcnt vmcnt(0)
    v_lshl_or_b32 v16, v9, 16, v8
    v_lshl_or_b32 v17, v11, 16, v10
    v_lshl_or_b32 v18, v13, 16, v12
    v_lshl_or_b32 v19, v15, 16, v14
    buffer_store_dwordx4 v[16:19], v5, s[8:11], 0 offen
L_pk_end:
    s_endpgm
.globl ln1_kernel
.p2align 8
.type ln1_kernel,@function
ln1_kernel:
    s_load_dwordx2 s[40:41], s[0:1], 0
    s_load_dwordx2 s[58:59], s[0:1], 96
    s_cmp_ge_u32 s2, 256
    s_cbranch_scc1 L_pack
    v_and_b32 v1, 63, v0
    v_lshrrev_b32 v2, 6, v0
    s_waitcnt lgkmcnt(0)
    s_mov_b32 s4, s40
    s_mov_b32 s5, s41
    s_mov_b32 s6, 2097152
    s_mov_b32 s7, 0x00020000
    s_mov_b32 s8, s58
    s_mov_b32 s9, s59
    s_mov_b32 s10, 2097152
    s_mov_b32 s11, 0x00020000
    s_add_u32 s12, s58, 16777216
    s_addc_u32 s13, s59, 0
    s_mov_b32 s14, 2097152
    s_mov_b32 s15, 0x00020000
    s_add_u32 s16, s58, 23068672
    s_addc_u32 s17, s59, 0
    s_mov_b32 s18, 2097152
    s_mov_b32 s19, 0x00020000
    s_lshl_b32 s60, s2, 4
    v_lshlrev_b32 v3, 12, v0
    v_add_u32 v3, s60, v3
    buffer_load_dwordx4 v[8:11], v3, s[8:11], 0 offen
    v_add_u32 v3, 0x100000, v3
    buffer_load_dwordx4 v[12:15], v3, s[8:11], 0 offen
    v_lshlrev_b32 v5, 1, v0
    s_waitcnt vmcnt(1)
    ds_write_b16 v5, v8 offset:0
    ds_write_b16_d16_hi v5, v8 offset:1024
    ds_write_b16 v5, v9 offset:2048
    ds_write_b16_d16_hi v5, v9 offset:3072
    ds_write_b16 v5, v10 offset:4096
    ds_write_b16_d16_hi v5, v10 offset:5120
    ds_write_b16 v5, v11 offset:6144
    ds_write_b16_d16_hi v5, v11 offset:7168
    s_waitcnt vmcnt(0)
    ds_write_b16 v5, v12 offset:512
    ds_write_b16_d16_hi v5, v12 offset:1536
    ds_write_b16 v5, v13 offset:2560
    ds_write_b16_d16_hi v5, v13 offset:3584
    ds_write_b16 v5, v14 offset:4608
    ds_write_b16_d16_hi v5, v14 offset:5632
    ds_write_b16 v5, v15 offset:6656
    ds_write_b16_d16_hi v5, v15 offset:7680
    s_waitcnt lgkmcnt(0)
    s_barrier
    s_lshl_b32 s60, s2, 3
    v_lshl_add_u32 v3, v2, 1, s60
    v_add_u32 v3, 0, v3
    v_and_b32 v6, 7, v3
    v_lshlrev_b32 v6, 10, v6
    v_lshl_add_u32 v6, v1, 4, v6
    ds_read_b128 v[12:15], v6
    v_lshlrev_b32 v4, 10, v3
    v_lshl_add_u32 v4, v1, 4, v4
    buffer_load_dwordx4 v[8:11], v4, s[4:7], 0 offen
    s_waitcnt vmcnt(0) lgkmcnt(0)
    v_lshlrev_b32 v16, 16, v8
    v_and_b32 v17, 0xffff0000, v8
    v_lshlrev_b32 v24, 16, v12
    v_and_b32 v25, 0xffff0000, v12
    v_lshlrev_b32 v18, 16, v9
    v_and_b32 v19, 0xffff0000, v9
    v_lshlrev_b32 v26, 16, v13
    v_and_b32 v27, 0xffff0000, v13
    v_lshlrev_b32 v20, 16, v10
    v_and_b32 v21, 0xffff0000, v10
    v_lshlrev_b32 v28, 16, v14
    v_and_b32 v29, 0xffff0000, v14
    v_lshlrev_b32 v22, 16, v11
    v_and_b32 v23, 0xffff0000, v11
    v_lshlrev_b32 v30, 16, v15
    v_and_b32 v31, 0xffff0000, v15
    v_add_f32 v122, v16, v17
    v_add_f32 v122, v122, v18
    v_add_f32 v122, v122, v19
    v_add_f32 v122, v122, v20
    v_add_f32 v122, v122, v21
    v_add_f32 v122, v122, v22
    v_add_f32 v122, v122, v23
    s_nop 1
    v_add_f32_dpp v122, v122, v122 row_shr:1 row_mask:0xf bank_mask:0xf
    s_nop 1
    v_add_f32_dpp v122, v122, v122 row_shr:2 row_mask:0xf bank_mask:0xf
    s_nop 1
    v_add_f32_dpp v122, v122, v122 row_shr:4 row_mask:0xf bank_mask:0xf
    s_nop 1
    v_add_f32_dpp v122, v122, v122 row_shr:8 row_mask:0xf bank_mask:0xf
    s_nop 1
    v_add_f32_dpp v122, v122, v122 row_bcast:15 row_mask:0xa bank_mask:0xf
    s_nop 1
    v_add_f32_dpp v122, v122, v122 row_bcast:31 row_mask:0xc bank_mask:0xf
    s_nop 1
    v_readlane_b32 s70, v122, 63
    s_nop 1
    v_mov_b32 v122, s70
    v_mul_f32 v122, 0x3b000000, v122
    v_sub_f32 v123, v16, v122
    v_mul_f32 v124, v123, v123
    v_sub_f32 v123, v17, v122
    v_fmac_f32 v124, v123, v123
    v_sub_f32 v123, v18, v122
    v_fmac_f32 v124, v123, v123
    v_sub_f32 v123, v19, v122
    v_fmac_f32 v124, v123, v123
    v_sub_f32 v123, v20, v122
    v_fmac_f32 v124, v123, v123
    v_sub_f32 v123, v21, v122
    v_fmac_f32 v124, v123, v123
    v_sub_f32 v123, v22, v122
    v_fmac_f32 v124, v123, v123
    v_sub_f32 v123, v23, v122
    v_fmac_f32 v124, v123, v123
    s_nop 1
    v_add_f32_dpp v124, v124, v124 row_shr:1 row_mask:0xf bank_mask:0xf
    s_nop 1
    v_add_f32_dpp v124, v124, v124 row_shr:2 row_mask:0xf bank_mask:0xf
    s_nop 1
    v_add_f32_dpp v124, v124, v124 row_shr:4 row_mask:0xf bank_mask:0xf
    s_nop 1
    v_add_f32_dpp v124, v124, v124 row_shr:8 row_mask:0xf bank_mask:0xf
    s_nop 1
    v_add_f32_dpp v124, v124, v124 row_bcast:15 row_mask:0xa bank_mask:0xf
    s_nop 1
    v_add_f32_dpp v124, v124, v124 row_bcast:31 row_mask:0xc bank_mask:0xf
    s_nop 1
    v_readlane_b32 s70, v124, 63
    s_nop 1
    v_mov_b32 v124, s70
    v_mul_f32 v124, 0x3b000000, v124
    v_cvt_pk_bf16_f32 v123, v122, v124
    v_lshlrev_b32 v120, 16, v123
    v_and_b32 v124, 0xffff0000, v123
    v_add_f32 v124, 0x3727c5ac, v124
    v_cvt_pk_bf16_f32 v124, v124, v124
    v_lshlrev_b32 v124, 16, v124
    v_sqrt_f32 v124, v124
    s_nop 0
    v_cvt_pk_bf16_f32 v124, v124, v124
    v_lshlrev_b32 v124, 16, v124
    v_rcp_f32 v121, v124
    s_nop 0
    v_sub_f32 v123, v16, v120
    v_sub_f32 v124, v17, v120
    v_cvt_pk_bf16_f32 v125, v123, v124
    v_lshlrev_b32 v123, 16, v125
    v_and_b32 v124, 0xffff0000, v125
    v_mul_f32 v123, v123, v121
    v_mul_f32 v124, v124, v121
    v_cvt_pk_bf16_f32 v32, v123, v124
    v_sub_f32 v123, v18, v120
    v_sub_f32 v124, v19, v120
    v_cvt_pk_bf16_f32 v125, v123, v124
    v_lshlrev_b32 v123, 16, v125
    v_and_b32 v124, 0xffff0000, v125
    v_mul_f32 v123, v123, v121
    v_mul_f32 v124, v124, v121
    v_cvt_pk_bf16_f32 v33, v123, v124
    v_sub_f32 v123, v20, v120
    v_sub_f32 v124, v21, v120
    v_cvt_pk_bf16_f32 v125, v123, v124
    v_lshlrev_b32 v123, 16, v125
    v_and_b32 v124, 0xffff0000, v125
    v_mul_f32 v123, v123, v121
    v_mul_f32 v124, v124, v121
    v_cvt_pk_bf16_f32 v34, v123, v124
    v_sub_f32 v123, v22, v120
    v_sub_f32 v124, v23, v120
    v_cvt_pk_bf16_f32 v125, v123, v124
    v_lshlrev_b32 v123, 16, v125
    v_and_b32 v124, 0xffff0000, v125
    v_mul_f32 v123, v123, v121
    v_mul_f32 v124, v124, v121
    v_cvt_pk_bf16_f32 v35, v123, v124
    v_lshlrev_b32 v123, 16, v32
    v_and_b32 v124, 0xffff0000, v32
    v_mul_f32 v123, v123, v24
    v_mul_f32 v124, v124, v25
    v_cvt_pk_bf16_f32 v125, v123, v124
    v_lshlrev_b32 v123, 16, v125
    v_and_b32 v124, 0xffff0000, v125
    v_add_f32 v123, v123, v16
    v_add_f32 v124, v124, v17
    v_cvt_pk_bf16_f32 v36, v123, v124
    v_lshlrev_b32 v16, 16, v36
    v_and_b32 v17, 0xffff0000, v36
    v_lshlrev_b32 v123, 16, v33
    v_and_b32 v124, 0xffff0000, v33
    v_mul_f32 v123, v123, v26
    v_mul_f32 v124, v124, v27
    v_cvt_pk_bf16_f32 v125, v123, v124
    v_lshlrev_b32 v123, 16, v125
    v_and_b32 v124, 0xffff0000, v125
    v_add_f32 v123, v123, v18
    v_add_f32 v124, v124, v19
    v_cvt_pk_bf16_f32 v37, v123, v124
    v_lshlrev_b32 v18, 16, v37
    v_and_b32 v19, 0xffff0000, v37
    v_lshlrev_b32 v123, 16, v34
    v_and_b32 v124, 0xffff0000, v34
    v_mul_f32 v123, v123, v28
    v_mul_f32 v124, v124, v29
    v_cvt_pk_bf16_f32 v125, v123, v124
    v_lshlrev_b32 v123, 16, v125
    v_and_b32 v124, 0xffff0000, v125
    v_add_f32 v123, v123, v20
    v_add_f32 v124, v124, v21
    v_cvt_pk_bf16_f32 v38, v123, v124
    v_lshlrev_b32 v20, 16, v38
    v_and_b32 v21, 0xffff0000, v38
    v_lshlrev_b32 v123, 16, v35
    v_and_b32 v124, 0xffff0000, v35
    v_mul_f32 v123, v123, v30
    v_mul_f32 v124, v124, v31
    v_cvt_pk_bf16_f32 v125, v123, v124
    v_lshlrev_b32 v123, 16, v125
    v_and_b32 v124, 0xffff0000, v125
    v_add_f32 v123, v123, v22
    v_add_f32 v124, v124, v23
    v_cvt_pk_bf16_f32 v39, v123, v124
    v_lshlrev_b32 v22, 16, v39
    v_and_b32 v23, 0xffff0000, v39
    buffer_store_dwordx4 v[36:39], v4, s[12:15], 0 offen
    v_add_f32 v122, v16, v17
    v_add_f32 v122, v122, v18
    v_add_f32 v122, v122, v19
    v_add_f32 v122, v122, v20
    v_add_f32 v122, v122, v21
    v_add_f32 v122, v122, v22
    v_add_f32 v122, v122, v23
    s_nop 1
    v_add_f32_dpp v122, v122, v122 row_shr:1 row_mask:0xf bank_mask:0xf
    s_nop 1
    v_add_f32_dpp v122, v122, v122 row_shr:2 row_mask:0xf bank_mask:0xf
    s_nop 1
    v_add_f32_dpp v122, v122, v122 row_shr:4 row_mask:0xf bank_mask:0xf
    s_nop 1
    v_add_f32_dpp v122, v122, v122 row_shr:8 row_mask:0xf bank_mask:0xf
    s_nop 1
    v_add_f32_dpp v122, v122, v122 row_bcast:15 row_mask:0xa bank_mask:0xf
    s_nop 1
    v_add_f32_dpp v122, v122, v122 row_bcast:31 row_mask:0xc bank_mask:0xf
    s_nop 1
    v_readlane_b32 s70, v122, 63
    s_nop 1
    v_mov_b32 v122, s70
    v_mul_f32 v122, 0x3b000000, v122
    v_sub_f32 v123, v16, v122
    v_mul_f32 v124, v123, v123
    v_sub_f32 v123, v17, v122
    v_fmac_f32 v124, v123, v123
    v_sub_f32 v123, v18, v122
    v_fmac_f32 v124, v123, v123
    v_sub_f32 v123, v19, v122
    v_fmac_f32 v124, v123, v123
    v_sub_f32 v123, v20, v122
    v_fmac_f32 v124, v123, v123
    v_sub_f32 v123, v21, v122
    v_fmac_f32 v124, v123, v123
    v_sub_f32 v123, v22, v122
    v_fmac_f32 v124, v123, v123
    v_sub_f32 v123, v23, v122
    v_fmac_f32 v124, v123, v123
    s_nop 1
    v_add_f32_dpp v124, v124, v124 row_shr:1 row_mask:0xf bank_mask:0xf
    s_nop 1
    v_add_f32_dpp v124, v124, v124 row_shr:2 row_mask:0xf bank_mask:0xf
    s_nop 1
    v_add_f32_dpp v124, v124, v124 row_shr:4 row_mask:0xf bank_mask:0xf
    s_nop 1
    v_add_f32_dpp v124, v124, v124 row_shr:8 row_mask:0xf bank_mask:0xf
    s_nop 1
    v_add_f32_dpp v124, v124, v124 row_bcast:15 row_mask:0xa bank_mask:0xf
    s_nop 1
    v_add_f32_dpp v124, v124, v124 row_bcast:31 row_mask:0xc bank_mask:0xf
    s_nop 1
    v_readlane_b32 s70, v124, 63
    s_nop 1
    v_mov_b32 v124, s70
    v_mul_f32 v124, 0x3b000000, v124
    v_cvt_pk_bf16_f32 v123, v122, v124
    v_lshlrev_b32 v120, 16, v123
    v_and_b32 v124, 0xffff0000, v123
    v_add_f32 v124, 0x3727c5ac, v124
    v_cvt_pk_bf16_f32 v124, v124, v124
    v_lshlrev_b32 v124, 16, v124
    v_sqrt_f32 v124, v124
    s_nop 0
    v_cvt_pk_bf16_f32 v124, v124, v124
    v_lshlrev_b32 v124, 16, v124
    v_rcp_f32 v121, v124
    s_nop 0
    v_sub_f32 v123, v16, v120
    v_sub_f32 v124, v17, v120
    v_cvt_pk_bf16_f32 v125, v123, v124
    v_lshlrev_b32 v123, 16, v125
    v_and_b32 v124, 0xffff0000, v125
    v_mul_f32 v123, v123, v121
    v_mul_f32 v124, v124, v121
    v_cvt_pk_bf16_f32 v40, v123, v124
    v_sub_f32 v123, v18, v120
    v_sub_f32 v124, v19, v120
    v_cvt_pk_bf16_f32 v125, v123, v124
    v_lshlrev_b32 v123, 16, v125
    v_and_b32 v124, 0xffff0000, v125
    v_mul_f32 v123, v123, v121
    v_mul_f32 v124, v124, v121
    v_cvt_pk_bf16_f32 v41, v123, v124
    v_sub_f32 v123, v20, v120
    v_sub_f32 v124, v21, v120
    v_cvt_pk_bf16_f32 v125, v123, v124
    v_lshlrev_b32 v123, 16, v125
    v_and_b32 v124, 0xffff0000, v125
    v_mul_f32 v123, v123, v121
    v_mul_f32 v124, v124, v121
    v_cvt_pk_bf16_f32 v42, v123, v124
    v_sub_f32 v123, v22, v120
    v_sub_f32 v124, v23, v120
    v_cvt_pk_bf16_f32 v125, v123, v124
    v_lshlrev_b32 v123, 16, v125
    v_and_b32 v124, 0xffff0000, v125
    v_mul_f32 v123, v123, v121
    v_mul_f32 v124, v124, v121
    v_cvt_pk_bf16_f32 v43, v123, v124
    v_lshrrev_b32 v5, 5, v3
    v_lshlrev_b32 v5, 15, v5
    v_lshrrev_b32 v6, 1, v1
    v_lshl_add_u32 v5, v6, 10, v5
    v_and_b32 v6, 1, v1
    v_lshl_add_u32 v5, v6, 9, v5
    v_and_b32 v6, 31, v3
    v_lshl_add_u32 v5, v6, 4, v5
    buffer_store_dwordx4 v[40:43], v5, s[16:19], 0 offen
    s_lshl_b32 s60, s2, 3
    v_lshl_add_u32 v3, v2, 1, s60
    v_add_u32 v3, 1, v3
    v_and_b32 v6, 7, v3
    v_lshlrev_b32 v6, 10, v6
    v_lshl_add_u32 v6, v1, 4, v6
    ds_read_b128 v[12:15], v6
    v_lshlrev_b32 v4, 10, v3
    v_lshl_add_u32 v4, v1, 4, v4
    buffer_load_dwordx4 v[8:11], v4, s[4:7], 0 offen
    s_waitcnt vmcnt(0) lgkmcnt(0)
    v_lshlrev_b32 v16, 16, v8
    v_and_b32 v17, 0xffff0000, v8
    v_lshlrev_b32 v24, 16, v12
    v_and_b32 v25, 0xffff0000, v12
    v_lshlrev_b32 v18, 16, v9
    v_and_b32 v19, 0xffff0000, v9
    v_lshlrev_b32 v26, 16, v13
    v_and_b32 v27, 0xffff0000, v13
    v_lshlrev_b32 v20, 16, v10
    v_and_b32 v21, 0xffff0000, v10
    v_lshlrev_b32 v28, 16, v14
    v_and_b32 v29, 0xffff0000, v14
    v_lshlrev_b32 v22, 16, v11
    v_and_b32 v23, 0xffff0000, v11
    v_lshlrev_b32 v30, 16, v15
    v_and_b32 v31, 0xffff0000, v15
    v_add_f32 v122, v16, v17
    v_add_f32 v122, v122, v18
    v_add_f32 v122, v122, v19
    v_add_f32 v122, v122, v20
    v_add_f32 v122, v122, v21
    v_add_f32 v122, v122, v22
    v_add_f32 v122, v122, v23
    s_nop 1
    v_add_f32_dpp v122, v122, v122 row_shr:1 row_mask:0xf bank_mask:0xf
    s_nop 1
    v_add_f32_dpp v122, v122, v122 row_shr:2 row_mask:0xf bank_mask:0xf
    s_nop 1
    v_add_f32_dpp v122, v122, v122 row_shr:4 row_mask:0xf bank_mask:0xf
    s_nop 1
    v_add_f32_dpp v122, v122, v122 row_shr:8 row_mask:0xf bank_mask:0xf
    s_nop 1
    v_add_f32_dpp v122, v122, v122 row_bcast:15 row_mask:0xa bank_mask:0xf
    s_nop 1
    v_add_f32_dpp v122, v122, v122 row_bcast:31 row_mask:0xc bank_mask:0xf
    s_nop 1
    v_readlane_b32 s70, v122, 63
    s_nop 1
    v_mov_b32 v122, s70
    v_mul_f32 v122, 0x3b000000, v122
    v_sub_f32 v123, v16, v122
    v_mul_f32 v124, v123, v123
    v_sub_f32 v123, v17, v122
    v_fmac_f32 v124, v123, v123
    v_sub_f32 v123, v18, v122
    v_fmac_f32 v124, v123, v123
    v_sub_f32 v123, v19, v122
    v_fmac_f32 v124, v123, v123
    v_sub_f32 v123, v20, v122
    v_fmac_f32 v124, v123, v123
    v_sub_f32 v123, v21, v122
    v_fmac_f32 v124, v123, v123
    v_sub_f32 v123, v22, v122
    v_fmac_f32 v124, v123, v123
    v_sub_f32 v123, v23, v122
    v_fmac_f32 v124, v123, v123
    s_nop 1
    v_add_f32_dpp v124, v124, v124 row_shr:1 row_mask:0xf bank_mask:0xf
    s_nop 1
    v_add_f32_dpp v124, v124, v124 row_shr:2 row_mask:0xf bank_mask:0xf
    s_nop 1
    v_add_f32_dpp v124, v124, v124 row_shr:4 row_mask:0xf bank_mask:0xf
    s_nop 1
    v_add_f32_dpp v124, v124, v124 row_shr:8 row_mask:0xf bank_mask:0xf
    s_nop 1
    v_add_f32_dpp v124, v124, v124 row_bcast:15 row_mask:0xa bank_mask:0xf
    s_nop 1
    v_add_f32_dpp v124, v124, v124 row_bcast:31 row_mask:0xc bank_mask:0xf
    s_nop 1
    v_readlane_b32 s70, v124, 63
    s_nop 1
    v_mov_b32 v124, s70
    v_mul_f32 v124, 0x3b000000, v124
    v_cvt_pk_bf16_f32 v123, v122, v124
    v_lshlrev_b32 v120, 16, v123
    v_and_b32 v124, 0xffff0000, v123
    v_add_f32 v124, 0x3727c5ac, v124
    v_cvt_pk_bf16_f32 v124, v124, v124
    v_lshlrev_b32 v124, 16, v124
    v_sqrt_f32 v124, v124
    s_nop 0
    v_cvt_pk_bf16_f32 v124, v124, v124
    v_lshlrev_b32 v124, 16, v124
    v_rcp_f32 v121, v124
    s_nop 0
    v_sub_f32 v123, v16, v120
    v_sub_f32 v124, v17, v120
    v_cvt_pk_bf16_f32 v125, v123, v124
    v_lshlrev_b32 v123, 16, v125
    v_and_b32 v124, 0xffff0000, v125
    v_mul_f32 v123, v123, v121
    v_mul_f32 v124, v124, v121
    v_cvt_pk_bf16_f32 v32, v123, v124
    v_sub_f32 v123, v18, v120
    v_sub_f32 v124, v19, v120
    v_cvt_pk_bf16_f32 v125, v123, v124
    v_lshlrev_b32 v123, 16, v125
    v_and_b32 v124, 0xffff0000, v125
    v_mul_f32 v123, v123, v121
    v_mul_f32 v124, v124, v121
    v_cvt_pk_bf16_f32 v33, v123, v124
    v_sub_f32 v123, v20, v120
    v_sub_f32 v124, v21, v120
    v_cvt_pk_bf16_f32 v125, v123, v124
    v_lshlrev_b32 v123, 16, v125
    v_and_b32 v124, 0xffff0000, v125
    v_mul_f32 v123, v123, v121
    v_mul_f32 v124, v124, v121
    v_cvt_pk_bf16_f32 v34, v123, v124
    v_sub_f32 v123, v22, v120
    v_sub_f32 v124, v23, v120
    v_cvt_pk_bf16_f32 v125, v123, v124
    v_lshlrev_b32 v123, 16, v125
    v_and_b32 v124, 0xffff0000, v125
    v_mul_f32 v123, v123, v121
    v_mul_f32 v124, v124, v121
    v_cvt_pk_bf16_f32 v35, v123, v124
    v_lshlrev_b32 v123, 16, v32
    v_and_b32 v124, 0xffff0000, v32
    v_mul_f32 v123, v123, v24
    v_mul_f32 v124, v124, v25
    v_cvt_pk_bf16_f32 v125, v123, v124
    v_lshlrev_b32 v123, 16, v125
    v_and_b32 v124, 0xffff0000, v125
    v_add_f32 v123, v123, v16
    v_add_f32 v124, v124, v17
    v_cvt_pk_bf16_f32 v36, v123, v124
    v_lshlrev_b32 v16, 16, v36
    v_and_b32 v17, 0xffff0000, v36
    v_lshlrev_b32 v123, 16, v33
    v_and_b32 v124, 0xffff0000, v33
    v_mul_f32 v123, v123, v26
    v_mul_f32 v124, v124, v27
    v_cvt_pk_bf16_f32 v125, v123, v124
    v_lshlrev_b32 v123, 16, v125
    v_and_b32 v124, 0xffff0000, v125
    v_add_f32 v123, v123, v18
    v_add_f32 v124, v124, v19
    v_cvt_pk_bf16_f32 v37, v123, v124
    v_lshlrev_b32 v18, 16, v37
    v_and_b32 v19, 0xffff0000, v37
    v_lshlrev_b32 v123, 16, v34
    v_and_b32 v124, 0xffff0000, v34
    v_mul_f32 v123, v123, v28
    v_mul_f32 v124, v124, v29
    v_cvt_pk_bf16_f32 v125, v123, v124
    v_lshlrev_b32 v123, 16, v125
    v_and_b32 v124, 0xffff0000, v125
    v_add_f32 v123, v123, v20
    v_add_f32 v124, v124, v21
    v_cvt_pk_bf16_f32 v38, v123, v124
    v_lshlrev_b32 v20, 16, v38
    v_and_b32 v21, 0xffff0000, v38
    v_lshlrev_b32 v123, 16, v35
    v_and_b32 v124, 0xffff0000, v35
    v_mul_f32 v123, v123, v30
    v_mul_f32 v124, v124, v31
    v_cvt_pk_bf16_f32 v125, v123, v124
    v_lshlrev_b32 v123, 16, v125
    v_and_b32 v124, 0xffff0000, v125
    v_add_f32 v123, v123, v22
    v_add_f32 v124, v124, v23
    v_cvt_pk_bf16_f32 v39, v123, v124
    v_lshlrev_b32 v22, 16, v39
    v_and_b32 v23, 0xffff0000, v39
    buffer_store_dwordx4 v[36:39], v4, s[12:15], 0 offen
    v_add_f32 v122, v16, v17
    v_add_f32 v122, v122, v18
    v_add_f32 v122, v122, v19
    v_add_f32 v122, v122, v20
    v_add_f32 v122, v122, v21
    v_add_f32 v122, v122, v22
    v_add_f32 v122, v122, v23
    s_nop 1
    v_add_f32_dpp v122, v122, v122 row_shr:1 row_mask:0xf bank_mask:0xf
    s_nop 1
    v_add_f32_dpp v122, v122, v122 row_shr:2 row_mask:0xf bank_mask:0xf
    s_nop 1
    v_add_f32_dpp v122, v122, v122 row_shr:4 row_mask:0xf bank_mask:0xf
    s_nop 1
    v_add_f32_dpp v122, v122, v122 row_shr:8 row_mask:0xf bank_mask:0xf
    s_nop 1
    v_add_f32_dpp v122, v122, v122 row_bcast:15 row_mask:0xa bank_mask:0xf
    s_nop 1
    v_add_f32_dpp v122, v122, v122 row_bcast:31 row_mask:0xc bank_mask:0xf
    s_nop 1
    v_readlane_b32 s70, v122, 63
    s_nop 1
    v_mov_b32 v122, s70
    v_mul_f32 v122, 0x3b000000, v122
    v_sub_f32 v123, v16, v122
    v_mul_f32 v124, v123, v123
    v_sub_f32 v123, v17, v122
    v_fmac_f32 v124, v123, v123
    v_sub_f32 v123, v18, v122
    v_fmac_f32 v124, v123, v123
    v_sub_f32 v123, v19, v122
    v_fmac_f32 v124, v123, v123
    v_sub_f32 v123, v20, v122
    v_fmac_f32 v124, v123, v123
    v_sub_f32 v123, v21, v122
    v_fmac_f32 v124, v123, v123
    v_sub_f32 v123, v22, v122
    v_fmac_f32 v124, v123, v123
    v_sub_f32 v123, v23, v122
    v_fmac_f32 v124, v123, v123
    s_nop 1
    v_add_f32_dpp v124, v124, v124 row_shr:1 row_mask:0xf bank_mask:0xf
    s_nop 1
    v_add_f32_dpp v124, v124, v124 row_shr:2 row_mask:0xf bank_mask:0xf
    s_nop 1
    v_add_f32_dpp v124, v124, v124 row_shr:4 row_mask:0xf bank_mask:0xf
    s_nop 1
    v_add_f32_dpp v124, v124, v124 row_shr:8 row_mask:0xf bank_mask:0xf
    s_nop 1
    v_add_f32_dpp v124, v124, v124 row_bcast:15 row_mask:0xa bank_mask:0xf
    s_nop 1
    v_add_f32_dpp v124, v124, v124 row_bcast:31 row_mask:0xc bank_mask:0xf
    s_nop 1
    v_readlane_b32 s70, v124, 63
    s_nop 1
    v_mov_b32 v124, s70
    v_mul_f32 v124, 0x3b000000, v124
    v_cvt_pk_bf16_f32 v123, v122, v124
    v_lshlrev_b32 v120, 16, v123
    v_and_b32 v124, 0xffff0000, v123
    v_add_f32 v124, 0x3727c5ac, v124
    v_cvt_pk_bf16_f32 v124, v124, v124
    v_lshlrev_b32 v124, 16, v124
    v_sqrt_f32 v124, v124
    s_nop 0
    v_cvt_pk_bf16_f32 v124, v124, v124
    v_lshlrev_b32 v124, 16, v124
    v_rcp_f32 v121, v124
    s_nop 0
    v_sub_f32 v123, v16, v120
    v_sub_f32 v124, v17, v120
    v_cvt_pk_bf16_f32 v125, v123, v124
    v_lshlrev_b32 v123, 16, v125
    v_and_b32 v124, 0xffff0000, v125
    v_mul_f32 v123, v123, v121
    v_mul_f32 v124, v124, v121
    v_cvt_pk_bf16_f32 v40, v123, v124
    v_sub_f32 v123, v18, v120
    v_sub_f32 v124, v19, v120
    v_cvt_pk_bf16_f32 v125, v123, v124
    v_lshlrev_b32 v123, 16, v125
    v_and_b32 v124, 0xffff0000, v125
    v_mul_f32 v123, v123, v121
    v_mul_f32 v124, v124, v121
    v_cvt_pk_bf16_f32 v41, v123, v124
    v_sub_f32 v123, v20, v120
    v_sub_f32 v124, v21, v120
    v_cvt_pk_bf16_f32 v125, v123, v124
    v_lshlrev_b32 v123, 16, v125
    v_and_b32 v124, 0xffff0000, v125
    v_mul_f32 v123, v123, v121
    v_mul_f32 v124, v124, v121
    v_cvt_pk_bf16_f32 v42, v123, v124
    v_sub_f32 v123, v22, v120
    v_sub_f32 v124, v23, v120
    v_cvt_pk_bf16_f32 v125, v123, v124
    v_lshlrev_b32 v123, 16, v125
    v_and_b32 v124, 0xffff0000, v125
    v_mul_f32 v123, v123, v121
    v_mul_f32 v124, v124, v121
    v_cvt_pk_bf16_f32 v43, v123, v124
    v_lshrrev_b32 v5, 5, v3
    v_lshlrev_b32 v5, 15, v5
    v_lshrrev_b32 v6, 1, v1
    v_lshl_add_u32 v5, v6, 10, v5
    v_and_b32 v6, 1, v1
    v_lshl_add_u32 v5, v6, 9, v5
    v_and_b32 v6, 31, v3
    v_lshl_add_u32 v5, v6, 4, v5
    buffer_store_dwordx4 v[40:43], v5, s[16:19], 0 offen
L_ln1_kernel_end:
    s_endpgm
.globl ln2_kernel
.p2align 8
.type ln2_kernel,@function
ln2_kernel:
    s_load_dwordx2 s[40:41], s[0:1], 0
    s_load_dwordx2 s[58:59], s[0:1], 96
    s_cmp_ge_u32 s2, 256
    s_cbranch_scc1 L_ln2_kernel_end
    v_and_b32 v1, 63, v0
    v_lshrrev_b32 v2, 6, v0
    s_waitcnt lgkmcnt(0)
    s_add_u32 s4, s58, 18874368
    s_addc_u32 s5, s59, 0
    s_mov_b32 s6, 2097152
    s_mov_b32 s7, 0x00020000
    s_mov_b32 s8, s58
    s_mov_b32 s9, s59
    s_mov_b32 s10, 2097152
    s_mov_b32 s11, 0x00020000
    s_add_u32 s12, s58, 20971520
    s_addc_u32 s13, s59, 0
    s_mov_b32 s14, 2097152
    s_mov_b32 s15, 0x00020000
    s_add_u32 s16, s58, 23068672
    s_addc_u32 s17, s59, 0
    s_mov_b32 s18, 2097152
    s_mov_b32 s19, 0x00020000
    s_lshl_b32 s60, s2, 4
    v_lshlrev_b32 v3, 12, v0
    v_add_u32 v3, s60, v3
    buffer_load_dwordx4 v[8:11], v3, s[8:11], 0 offen
    v_add_u32 v3, 0x100000, v3
    buffer_load_dwordx4 v[12:15], v3, s[8:11], 0 offen
    v_lshlrev_b32 v5, 1, v0
    s_waitcnt vmcnt(1)
    ds_write_b16 v5, v8 offset:0
    ds_write_b16_d16_hi v5, v8 offset:1024
    ds_write_b16 v5, v9 offset:2048
    ds_write_b16_d16_hi v5, v9 offset:3072
    ds_write_b16 v5, v10 offset:4096
    ds_write_b16_d16_hi v5, v10 offset:5120
    ds_write_b16 v5, v11 offset:6144
    ds_write_b16_d16_hi v5, v11 offset:7168
    s_waitcnt vmcnt(0)
    ds_write_b16 v5, v12 offset:512
    ds_write_b16_d16_hi v5, v12 offset:1536
    ds_write_b16 v5, v13 offset:2560
    ds_write_b16_d16_hi v5, v13 offset:3584
    ds_write_b16 v5, v14 offset:4608
    ds_write_b16_d16_hi v5, v14 offset:5632
    ds_write_b16 v5, v15 offset:6656
    ds_write_b16_d16_hi v5, v15 offset:7680
    s_waitcnt lgkmcnt(0)
    s_barrier
    s_lshl_b32 s60, s2, 3
    v_lshl_add_u32 v3, v2, 1, s60
    v_add_u32 v3, 0, v3
    v_and_b32 v6, 7, v3
    v_lshlrev_b32 v6, 10, v6
    v_lshl_add_u32 v6, v1, 4, v6
    ds_read_b128 v[12:15], v6
    v_lshlrev_b32 v4, 10, v3
    v_lshl_add_u32 v4, v1, 4, v4
    buffer_load_dwordx4 v[8:11], v4, s[4:7], 0 offen
    s_waitcnt vmcnt(0) lgkmcnt(0)
    v_lshlrev_b32 v16, 16, v8
    v_and_b32 v17, 0xffff0000, v8
    v_lshlrev_b32 v24, 16, v12
    v_and_b32 v25, 0xffff0000, v12
    v_lshlrev_b32 v18, 16, v9
    v_and_b32 v19, 0xffff0000, v9
    v_lshlrev_b32 v26, 16, v13
    v_and_b32 v27, 0xffff0000, v13
    v_lshlrev_b32 v20, 16, v10
    v_and_b32 v21, 0xffff0000, v10
    v_lshlrev_b32 v28, 16, v14
    v_and_b32 v29, 0xffff0000, v14
    v_lshlrev_b32 v22, 16, v11
    v_and_b32 v23, 0xffff0000, v11
    v_lshlrev_b32 v30, 16, v15
    v_and_b32 v31, 0xffff0000, v15
    v_add_f32 v122, v16, v17
    v_add_f32 v122, v122, v18
    v_add_f32 v122, v122, v19
    v_add_f32 v122, v122, v20
    v_add_f32 v122, v122, v21
    v_add_f32 v122, v122, v22
    v_add_f32 v122, v122, v23
    s_nop 1
    v_add_f32_dpp v122, v122, v122 row_shr:1 row_mask:0xf bank_mask:0xf
    s_nop 1
    v_add_f32_dpp v122, v122, v122 row_shr:2 row_mask:0xf bank_mask:0xf
    s_nop 1
    v_add_f32_dpp v122, v122, v122 row_shr:4 row_mask:0xf bank_mask:0xf
    s_nop 1
    v_add_f32_dpp v122, v122, v122 row_shr:8 row_mask:0xf bank_mask:0xf
    s_nop 1
    v_add_f32_dpp v122, v122, v122 row_bcast:15 row_mask:0xa bank_mask:0xf
    s_nop 1
    v_add_f32_dpp v122, v122, v122 row_bcast:31 row_mask:0xc bank_mask:0xf
    s_nop 1
    v_readlane_b32 s70, v122, 63
    s_nop 1
    v_mov_b32 v122, s70
    v_mul_f32 v122, 0x3b000000, v122
    v_sub_f32 v123, v16, v122
    v_mul_f32 v124, v123, v123
    v_sub_f32 v123, v17, v122
    v_fmac_f32 v124, v123, v123
    v_sub_f32 v123, v18, v122
    v_fmac_f32 v124, v123, v123
    v_sub_f32 v123, v19, v122
    v_fmac_f32 v124, v123, v123
    v_sub_f32 v123, v20, v122
    v_fmac_f32 v124, v123, v123
    v_sub_f32 v123, v21, v122
    v_fmac_f32 v124, v123, v123
    v_sub_f32 v123, v22, v122
    v_fmac_f32 v124, v123, v123
    v_sub_f32 v123, v23, v122
    v_fmac_f32 v124, v123, v123
    s_nop 1
    v_add_f32_dpp v124, v124, v124 row_shr:1 row_mask:0xf bank_mask:0xf
    s_nop 1
    v_add_f32_dpp v124, v124, v124 row_shr:2 row_mask:0xf bank_mask:0xf
    s_nop 1
    v_add_f32_dpp v124, v124, v124 row_shr:4 row_mask:0xf bank_mask:0xf
    s_nop 1
    v_add_f32_dpp v124, v124, v124 row_shr:8 row_mask:0xf bank_mask:0xf
    s_nop 1
    v_add_f32_dpp v124, v124, v124 row_bcast:15 row_mask:0xa bank_mask:0xf
    s_nop 1
    v_add_f32_dpp v124, v124, v124 row_bcast:31 row_mask:0xc bank_mask:0xf
    s_nop 1
    v_readlane_b32 s70, v124, 63
    s_nop 1
    v_mov_b32 v124, s70
    v_mul_f32 v124, 0x3b000000, v124
    v_cvt_pk_bf16_f32 v123, v122, v124
    v_lshlrev_b32 v120, 16, v123
    v_and_b32 v124, 0xffff0000, v123
    v_add_f32 v124, 0x3727c5ac, v124
    v_cvt_pk_bf16_f32 v124, v124, v124
    v_lshlrev_b32 v124, 16, v124
    v_sqrt_f32 v124, v124
    s_nop 0
    v_cvt_pk_bf16_f32 v124, v124, v124
    v_lshlrev_b32 v124, 16, v124
    v_rcp_f32 v121, v124
    s_nop 0
    v_sub_f32 v123, v16, v120
    v_sub_f32 v124, v17, v120
    v_cvt_pk_bf16_f32 v125, v123, v124
    v_lshlrev_b32 v123, 16, v125
    v_and_b32 v124, 0xffff0000, v125
    v_mul_f32 v123, v123, v121
    v_mul_f32 v124, v124, v121
    v_cvt_pk_bf16_f32 v32, v123, v124
    v_sub_f32 v123, v18, v120
    v_sub_f32 v124, v19, v120
    v_cvt_pk_bf16_f32 v125, v123, v124
    v_lshlrev_b32 v123, 16, v125
    v_and_b32 v124, 0xffff0000, v125
    v_mul_f32 v123, v123, v121
    v_mul_f32 v124, v124, v121
    v_cvt_pk_bf16_f32 v33, v123, v124
    v_sub_f32 v123, v20, v120
    v_sub_f32 v124, v21, v120
    v_cvt_pk_bf16_f32 v125, v123, v124
    v_lshlrev_b32 v123, 16, v125
    v_and_b32 v124, 0xffff0000, v125
    v_mul_f32 v123, v123, v121
    v_mul_f32 v124, v124, v121
    v_cvt_pk_bf16_f32 v34, v123, v124
    v_sub_f32 v123, v22, v120
    v_sub_f32 v124, v23, v120
    v_cvt_pk_bf16_f32 v125, v123, v124
    v_lshlrev_b32 v123, 16, v125
    v_and_b32 v124, 0xffff0000, v125
    v_mul_f32 v123, v123, v121
    v_mul_f32 v124, v124, v121
    v_cvt_pk_bf16_f32 v35, v123, v124
    v_lshlrev_b32 v123, 16, v32
    v_and_b32 v124, 0xffff0000, v32
    v_mul_f32 v123, v123, v24
    v_mul_f32 v124, v124, v25
    v_cvt_pk_bf16_f32 v125, v123, v124
    v_lshlrev_b32 v123, 16, v125
    v_and_b32 v124, 0xffff0000, v125
    v_add_f32 v123, v123, v16
    v_add_f32 v124, v124, v17
    v_cvt_pk_bf16_f32 v36, v123, v124
    v_lshlrev_b32 v16, 16, v36
    v_and_b32 v17, 0xffff0000, v36
    v_lshlrev_b32 v123, 16, v33
    v_and_b32 v124, 0xffff0000, v33
    v_mul_f32 v123, v123, v26
    v_mul_f32 v124, v124, v27
    v_cvt_pk_bf16_f32 v125, v123, v124
    v_lshlrev_b32 v123, 16, v125
    v_and_b32 v124, 0xffff0000, v125
    v_add_f32 v123, v123, v18
    v_add_f32 v124, v124, v19
    v_cvt_pk_bf16_f32 v37, v123, v124
    v_lshlrev_b32 v18, 16, v37
    v_and_b32 v19, 0xffff0000, v37
    v_lshlrev_b32 v123, 16, v34
    v_and_b32 v124, 0xffff0000, v34
    v_mul_f32 v123, v123, v28
    v_mul_f32 v124, v124, v29
    v_cvt_pk_bf16_f32 v125, v123, v124
    v_lshlrev_b32 v123, 16, v125
    v_and_b32 v124, 0xffff0000, v125
    v_add_f32 v123, v123, v20
    v_add_f32 v124, v124, v21
    v_cvt_pk_bf16_f32 v38, v123, v124
    v_lshlrev_b32 v20, 16, v38
    v_and_b32 v21, 0xffff0000, v38
    v_lshlrev_b32 v123, 16, v35
    v_and_b32 v124, 0xffff0000, v35
    v_mul_f32 v123, v123, v30
    v_mul_f32 v124, v124, v31
    v_cvt_pk_bf16_f32 v125, v123, v124
    v_lshlrev_b32 v123, 16, v125
    v_and_b32 v124, 0xffff0000, v125
    v_add_f32 v123, v123, v22
    v_add_f32 v124, v124, v23
    v_cvt_pk_bf16_f32 v39, v123, v124
    v_lshlrev_b32 v22, 16, v39
    v_and_b32 v23, 0xffff0000, v39
    buffer_store_dwordx4 v[36:39], v4, s[12:15], 0 offen
    v_add_f32 v122, v16, v17
    v_add_f32 v122, v122, v18
    v_add_f32 v122, v122, v19
    v_add_f32 v122, v122, v20
    v_add_f32 v122, v122, v21
    v_add_f32 v122, v122, v22
    v_add_f32 v122, v122, v23
    s_nop 1
    v_add_f32_dpp v122, v122, v122 row_shr:1 row_mask:0xf bank_mask:0xf
    s_nop 1
    v_add_f32_dpp v122, v122, v122 row_shr:2 row_mask:0xf bank_mask:0xf
    s_nop 1
    v_add_f32_dpp v122, v122, v122 row_shr:4 row_mask:0xf bank_mask:0xf
    s_nop 1
    v_add_f32_dpp v122, v122, v122 row_shr:8 row_mask:0xf bank_mask:0xf
    s_nop 1
    v_add_f32_dpp v122, v122, v122 row_bcast:15 row_mask:0xa bank_mask:0xf
    s_nop 1
    v_add_f32_dpp v122, v122, v122 row_bcast:31 row_mask:0xc bank_mask:0xf
    s_nop 1
    v_readlane_b32 s70, v122, 63
    s_nop 1
    v_mov_b32 v122, s70
    v_mul_f32 v122, 0x3b000000, v122
    v_sub_f32 v123, v16, v122
    v_mul_f32 v124, v123, v123
    v_sub_f32 v123, v17, v122
    v_fmac_f32 v124, v123, v123
    v_sub_f32 v123, v18, v122
    v_fmac_f32 v124, v123, v123
    v_sub_f32 v123, v19, v122
    v_fmac_f32 v124, v123, v123
    v_sub_f32 v123, v20, v122
    v_fmac_f32 v124, v123, v123
    v_sub_f32 v123, v21, v122
    v_fmac_f32 v124, v123, v123
    v_sub_f32 v123, v22, v122
    v_fmac_f32 v124, v123, v123
    v_sub_f32 v123, v23, v122
    v_fmac_f32 v124, v123, v123
    s_nop 1
    v_add_f32_dpp v124, v124, v124 row_shr:1 row_mask:0xf bank_mask:0xf
    s_nop 1
    v_add_f32_dpp v124, v124, v124 row_shr:2 row_mask:0xf bank_mask:0xf
    s_nop 1
    v_add_f32_dpp v124, v124, v124 row_shr:4 row_mask:0xf bank_mask:0xf
    s_nop 1
    v_add_f32_dpp v124, v124, v124 row_shr:8 row_mask:0xf bank_mask:0xf
    s_nop 1
    v_add_f32_dpp v124, v124, v124 row_bcast:15 row_mask:0xa bank_mask:0xf
    s_nop 1
    v_add_f32_dpp v124, v124, v124 row_bcast:31 row_mask:0xc bank_mask:0xf
    s_nop 1
    v_readlane_b32 s70, v124, 63
    s_nop 1
    v_mov_b32 v124, s70
    v_mul_f32 v124, 0x3b000000, v124
    v_cvt_pk_bf16_f32 v123, v122, v124
    v_lshlrev_b32 v120, 16, v123
    v_and_b32 v124, 0xffff0000, v123
    v_add_f32 v124, 0x3727c5ac, v124
    v_cvt_pk_bf16_f32 v124, v124, v124
    v_lshlrev_b32 v124, 16, v124
    v_sqrt_f32 v124, v124
    s_nop 0
    v_cvt_pk_bf16_f32 v124, v124, v124
    v_lshlrev_b32 v124, 16, v124
    v_rcp_f32 v121, v124
    s_nop 0
    v_sub_f32 v123, v16, v120
    v_sub_f32 v124, v17, v120
    v_cvt_pk_bf16_f32 v125, v123, v124
    v_lshlrev_b32 v123, 16, v125
    v_and_b32 v124, 0xffff0000, v125
    v_mul_f32 v123, v123, v121
    v_mul_f32 v124, v124, v121
    v_cvt_pk_bf16_f32 v40, v123, v124
    v_sub_f32 v123, v18, v120
    v_sub_f32 v124, v19, v120
    v_cvt_pk_bf16_f32 v125, v123, v124
    v_lshlrev_b32 v123, 16, v125
    v_and_b32 v124, 0xffff0000, v125
    v_mul_f32 v123, v123, v121
    v_mul_f32 v124, v124, v121
    v_cvt_pk_bf16_f32 v41, v123, v124
    v_sub_f32 v123, v20, v120
    v_sub_f32 v124, v21, v120
    v_cvt_pk_bf16_f32 v125, v123, v124
    v_lshlrev_b32 v123, 16, v125
    v_and_b32 v124, 0xffff0000, v125
    v_mul_f32 v123, v123, v121
    v_mul_f32 v124, v124, v121
    v_cvt_pk_bf16_f32 v42, v123, v124
    v_sub_f32 v123, v22, v120
    v_sub_f32 v124, v23, v120
    v_cvt_pk_bf16_f32 v125, v123, v124
    v_lshlrev_b32 v123, 16, v125
    v_and_b32 v124, 0xffff0000, v125
    v_mul_f32 v123, v123, v121
    v_mul_f32 v124, v124, v121
    v_cvt_pk_bf16_f32 v43, v123, v124
    v_lshrrev_b32 v5, 5, v3
    v_lshlrev_b32 v5, 15, v5
    v_lshrrev_b32 v6, 1, v1
    v_lshl_add_u32 v5, v6, 10, v5
    v_and_b32 v6, 1, v1
    v_lshl_add_u32 v5, v6, 9, v5
    v_and_b32 v6, 31, v3
    v_lshl_add_u32 v5, v6, 4, v5
    buffer_store_dwordx4 v[40:43], v5, s[16:19], 0 offen
    s_lshl_b32 s60, s2, 3
    v_lshl_add_u32 v3, v2, 1, s60
    v_add_u32 v3, 1, v3
    v_and_b32 v6, 7, v3
    v_lshlrev_b32 v6, 10, v6
    v_lshl_add_u32 v6, v1, 4, v6
    ds_read_b128 v[12:15], v6
    v_lshlrev_b32 v4, 10, v3
    v_lshl_add_u32 v4, v1, 4, v4
    buffer_load_dwordx4 v[8:11], v4, s[4:7], 0 offen
    s_waitcnt vmcnt(0) lgkmcnt(0)
    v_lshlrev_b32 v16, 16, v8
    v_and_b32 v17, 0xffff0000, v8
    v_lshlrev_b32 v24, 16, v12
    v_and_b32 v25, 0xffff0000, v12
    v_lshlrev_b32 v18, 16, v9
    v_and_b32 v19, 0xffff0000, v9
    v_lshlrev_b32 v26, 16, v13
    v_and_b32 v27, 0xffff0000, v13
    v_lshlrev_b32 v20, 16, v10
    v_and_b32 v21, 0xffff0000, v10
    v_lshlrev_b32 v28, 16, v14
    v_and_b32 v29, 0xffff0000, v14
    v_lshlrev_b32 v22, 16, v11
    v_and_b32 v23, 0xffff0000, v11
    v_lshlrev_b32 v30, 16, v15
    v_and_b32 v31, 0xffff0000, v15
    v_add_f32 v122, v16, v17
    v_add_f32 v122, v122, v18
    v_add_f32 v122, v122, v19
    v_add_f32 v122, v122, v20
    v_add_f32 v122, v122, v21
    v_add_f32 v122, v122, v22
    v_add_f32 v122, v122, v23
    s_nop 1
    v_add_f32_dpp v122, v122, v122 row_shr:1 row_mask:0xf bank_mask:0xf
    s_nop 1
    v_add_f32_dpp v122, v122, v122 row_shr:2 row_mask:0xf bank_mask:0xf
    s_nop 1
    v_add_f32_dpp v122, v122, v122 row_shr:4 row_mask:0xf bank_mask:0xf
    s_nop 1
    v_add_f32_dpp v122, v122, v122 row_shr:8 row_mask:0xf bank_mask:0xf
    s_nop 1
    v_add_f32_dpp v122, v122, v122 row_bcast:15 row_mask:0xa bank_mask:0xf
    s_nop 1
    v_add_f32_dpp v122, v122, v122 row_bcast:31 row_mask:0xc bank_mask:0xf
    s_nop 1
    v_readlane_b32 s70, v122, 63
    s_nop 1
    v_mov_b32 v122, s70
    v_mul_f32 v122, 0x3b000000, v122
    v_sub_f32 v123, v16, v122
    v_mul_f32 v124, v123, v123
    v_sub_f32 v123, v17, v122
    v_fmac_f32 v124, v123, v123
    v_sub_f32 v123, v18, v122
    v_fmac_f32 v124, v123, v123
    v_sub_f32 v123, v19, v122
    v_fmac_f32 v124, v123, v123
    v_sub_f32 v123, v20, v122
    v_fmac_f32 v124, v123, v123
    v_sub_f32 v123, v21, v122
    v_fmac_f32 v124, v123, v123
    v_sub_f32 v123, v22, v122
    v_fmac_f32 v124, v123, v123
    v_sub_f32 v123, v23, v122
    v_fmac_f32 v124, v123, v123
    s_nop 1
    v_add_f32_dpp v124, v124, v124 row_shr:1 row_mask:0xf bank_mask:0xf
    s_nop 1
    v_add_f32_dpp v124, v124, v124 row_shr:2 row_mask:0xf bank_mask:0xf
    s_nop 1
    v_add_f32_dpp v124, v124, v124 row_shr:4 row_mask:0xf bank_mask:0xf
    s_nop 1
    v_add_f32_dpp v124, v124, v124 row_shr:8 row_mask:0xf bank_mask:0xf
    s_nop 1
    v_add_f32_dpp v124, v124, v124 row_bcast:15 row_mask:0xa bank_mask:0xf
    s_nop 1
    v_add_f32_dpp v124, v124, v124 row_bcast:31 row_mask:0xc bank_mask:0xf
    s_nop 1
    v_readlane_b32 s70, v124, 63
    s_nop 1
    v_mov_b32 v124, s70
    v_mul_f32 v124, 0x3b000000, v124
    v_cvt_pk_bf16_f32 v123, v122, v124
    v_lshlrev_b32 v120, 16, v123
    v_and_b32 v124, 0xffff0000, v123
    v_add_f32 v124, 0x3727c5ac, v124
    v_cvt_pk_bf16_f32 v124, v124, v124
    v_lshlrev_b32 v124, 16, v124
    v_sqrt_f32 v124, v124
    s_nop 0
    v_cvt_pk_bf16_f32 v124, v124, v124
    v_lshlrev_b32 v124, 16, v124
    v_rcp_f32 v121, v124
    s_nop 0
    v_sub_f32 v123, v16, v120
    v_sub_f32 v124, v17, v120
    v_cvt_pk_bf16_f32 v125, v123, v124
    v_lshlrev_b32 v123, 16, v125
    v_and_b32 v124, 0xffff0000, v125
    v_mul_f32 v123, v123, v121
    v_mul_f32 v124, v124, v121
    v_cvt_pk_bf16_f32 v32, v123, v124
    v_sub_f32 v123, v18, v120
    v_sub_f32 v124, v19, v120
    v_cvt_pk_bf16_f32 v125, v123, v124
    v_lshlrev_b32 v123, 16, v125
    v_and_b32 v124, 0xffff0000, v125
    v_mul_f32 v123, v123, v121
    v_mul_f32 v124, v124, v121
    v_cvt_pk_bf16_f32 v33, v123, v124
    v_sub_f32 v123, v20, v120
    v_sub_f32 v124, v21, v120
    v_cvt_pk_bf16_f32 v125, v123, v124
    v_lshlrev_b32 v123, 16, v125
    v_and_b32 v124, 0xffff0000, v125
    v_mul_f32 v123, v123, v121
    v_mul_f32 v124, v124, v121
    v_cvt_pk_bf16_f32 v34, v123, v124
    v_sub_f32 v123, v22, v120
    v_sub_f32 v124, v23, v120
    v_cvt_pk_bf16_f32 v125, v123, v124
    v_lshlrev_b32 v123, 16, v125
    v_and_b32 v124, 0xffff0000, v125
    v_mul_f32 v123, v123, v121
    v_mul_f32 v124, v124, v121
    v_cvt_pk_bf16_f32 v35, v123, v124
    v_lshlrev_b32 v123, 16, v32
    v_and_b32 v124, 0xffff0000, v32
    v_mul_f32 v123, v123, v24
    v_mul_f32 v124, v124, v25
    v_cvt_pk_bf16_f32 v125, v123, v124
    v_lshlrev_b32 v123, 16, v125
    v_and_b32 v124, 0xffff0000, v125
    v_add_f32 v123, v123, v16
    v_add_f32 v124, v124, v17
    v_cvt_pk_bf16_f32 v36, v123, v124
    v_lshlrev_b32 v16, 16, v36
    v_and_b32 v17, 0xffff0000, v36
    v_lshlrev_b32 v123, 16, v33
    v_and_b32 v124, 0xffff0000, v33
    v_mul_f32 v123, v123, v26
    v_mul_f32 v124, v124, v27
    v_cvt_pk_bf16_f32 v125, v123, v124
    v_lshlrev_b32 v123, 16, v125
    v_and_b32 v124, 0xffff0000, v125
    v_add_f32 v123, v123, v18
    v_add_f32 v124, v124, v19
    v_cvt_pk_bf16_f32 v37, v123, v124
    v_lshlrev_b32 v18, 16, v37
    v_and_b32 v19, 0xffff0000, v37
    v_lshlrev_b32 v123, 16, v34
    v_and_b32 v124, 0xffff0000, v34
    v_mul_f32 v123, v123, v28
    v_mul_f32 v124, v124, v29
    v_cvt_pk_bf16_f32 v125, v123, v124
    v_lshlrev_b32 v123, 16, v125
    v_and_b32 v124, 0xffff0000, v125
    v_add_f32 v123, v123, v20
    v_add_f32 v124, v124, v21
    v_cvt_pk_bf16_f32 v38, v123, v124
    v_lshlrev_b32 v20, 16, v38
    v_and_b32 v21, 0xffff0000, v38
    v_lshlrev_b32 v123, 16, v35
    v_and_b32 v124, 0xffff0000, v35
    v_mul_f32 v123, v123, v30
    v_mul_f32 v124, v124, v31
    v_cvt_pk_bf16_f32 v125, v123, v124
    v_lshlrev_b32 v123, 16, v125
    v_and_b32 v124, 0xffff0000, v125
    v_add_f32 v123, v123, v22
    v_add_f32 v124, v124, v23
    v_cvt_pk_bf16_f32 v39, v123, v124
    v_lshlrev_b32 v22, 16, v39
    v_and_b32 v23, 0xffff0000, v39
    buffer_store_dwordx4 v[36:39], v4, s[12:15], 0 offen
    v_add_f32 v122, v16, v17
    v_add_f32 v122, v122, v18
    v_add_f32 v122, v122, v19
    v_add_f32 v122, v122, v20
    v_add_f32 v122, v122, v21
    v_add_f32 v122, v122, v22
    v_add_f32 v122, v122, v23
    s_nop 1
    v_add_f32_dpp v122, v122, v122 row_shr:1 row_mask:0xf bank_mask:0xf
    s_nop 1
    v_add_f32_dpp v122, v122, v122 row_shr:2 row_mask:0xf bank_mask:0xf
    s_nop 1
    v_add_f32_dpp v122, v122, v122 row_shr:4 row_mask:0xf bank_mask:0xf
    s_nop 1
    v_add_f32_dpp v122, v122, v122 row_shr:8 row_mask:0xf bank_mask:0xf
    s_nop 1
    v_add_f32_dpp v122, v122, v122 row_bcast:15 row_mask:0xa bank_mask:0xf
    s_nop 1
    v_add_f32_dpp v122, v122, v122 row_bcast:31 row_mask:0xc bank_mask:0xf
    s_nop 1
    v_readlane_b32 s70, v122, 63
    s_nop 1
    v_mov_b32 v122, s70
    v_mul_f32 v122, 0x3b000000, v122
    v_sub_f32 v123, v16, v122
    v_mul_f32 v124, v123, v123
    v_sub_f32 v123, v17, v122
    v_fmac_f32 v124, v123, v123
    v_sub_f32 v123, v18, v122
    v_fmac_f32 v124, v123, v123
    v_sub_f32 v123, v19, v122
    v_fmac_f32 v124, v123, v123
    v_sub_f32 v123, v20, v122
    v_fmac_f32 v124, v123, v123
    v_sub_f32 v123, v21, v122
    v_fmac_f32 v124, v123, v123
    v_sub_f32 v123, v22, v122
    v_fmac_f32 v124, v123, v123
    v_sub_f32 v123, v23, v122
    v_fmac_f32 v124, v123, v123
    s_nop 1
    v_add_f32_dpp v124, v124, v124 row_shr:1 row_mask:0xf bank_mask:0xf
    s_nop 1
    v_add_f32_dpp v124, v124, v124 row_shr:2 row_mask:0xf bank_mask:0xf
    s_nop 1
    v_add_f32_dpp v124, v124, v124 row_shr:4 row_mask:0xf bank_mask:0xf
    s_nop 1
    v_add_f32_dpp v124, v124, v124 row_shr:8 row_mask:0xf bank_mask:0xf
    s_nop 1
    v_add_f32_dpp v124, v124, v124 row_bcast:15 row_mask:0xa bank_mask:0xf
    s_nop 1
    v_add_f32_dpp v124, v124, v124 row_bcast:31 row_mask:0xc bank_mask:0xf
    s_nop 1
    v_readlane_b32 s70, v124, 63
    s_nop 1
    v_mov_b32 v124, s70
    v_mul_f32 v124, 0x3b000000, v124
    v_cvt_pk_bf16_f32 v123, v122, v124
    v_lshlrev_b32 v120, 16, v123
    v_and_b32 v124, 0xffff0000, v123
    v_add_f32 v124, 0x3727c5ac, v124
    v_cvt_pk_bf16_f32 v124, v124, v124
    v_lshlrev_b32 v124, 16, v124
    v_sqrt_f32 v124, v124
    s_nop 0
    v_cvt_pk_bf16_f32 v124, v124, v124
    v_lshlrev_b32 v124, 16, v124
    v_rcp_f32 v121, v124
    s_nop 0
    v_sub_f32 v123, v16, v120
    v_sub_f32 v124, v17, v120
    v_cvt_pk_bf16_f32 v125, v123, v124
    v_lshlrev_b32 v123, 16, v125
    v_and_b32 v124, 0xffff0000, v125
    v_mul_f32 v123, v123, v121
    v_mul_f32 v124, v124, v121
    v_cvt_pk_bf16_f32 v40, v123, v124
    v_sub_f32 v123, v18, v120
    v_sub_f32 v124, v19, v120
    v_cvt_pk_bf16_f32 v125, v123, v124
    v_lshlrev_b32 v123, 16, v125
    v_and_b32 v124, 0xffff0000, v125
    v_mul_f32 v123, v123, v121
    v_mul_f32 v124, v124, v121
    v_cvt_pk_bf16_f32 v41, v123, v124
    v_sub_f32 v123, v20, v120
    v_sub_f32 v124, v21, v120
    v_cvt_pk_bf16_f32 v125, v123, v124
    v_lshlrev_b32 v123, 16, v125
    v_and_b32 v124, 0xffff0000, v125
    v_mul_f32 v123, v123, v121
    v_mul_f32 v124, v124, v121
    v_cvt_pk_bf16_f32 v42, v123, v124
    v_sub_f32 v123, v22, v120
    v_sub_f32 v124, v23, v120
    v_cvt_pk_bf16_f32 v125, v123, v124
    v_lshlrev_b32 v123, 16, v125
    v_and_b32 v124, 0xffff0000, v125
    v_mul_f32 v123, v123, v121
    v_mul_f32 v124, v124, v121
    v_cvt_pk_bf16_f32 v43, v123, v124
    v_lshrrev_b32 v5, 5, v3
    v_lshlrev_b32 v5, 15, v5
    v_lshrrev_b32 v6, 1, v1
    v_lshl_add_u32 v5, v6, 10, v5
    v_and_b32 v6, 1, v1
    v_lshl_add_u32 v5, v6, 9, v5
    v_and_b32 v6, 31, v3
    v_lshl_add_u32 v5, v6, 4, v5
    buffer_store_dwordx4 v[40:43], v5, s[16:19], 0 offen
L_ln2_kernel_end:
    s_endpgm
.globl g1_kernel
.p2align 8
.type g1_kernel,@function
g1_kernel:
    s_load_dwordx2 s[58:59], s[0:1], 96
    s_cmp_ge_u32 s2, 352
    s_cbranch_scc1 L_g1_kernel_end
    v_and_b32 v1, 63, v0
    v_lshrrev_b32 v2, 6, v0
    s_and_b32 s60, s2, 31
    s_lshr_b32 s61, s2, 5
    s_waitcnt lgkmcnt(0)
    s_add_u32 s4, s58, 23068672
    s_addc_u32 s5, s59, 0
    s_mov_b32 s6, 2097152
    s_mov_b32 s7, 0x00020000
    s_add_u32 s8, s58, 2097152
    s_addc_u32 s9, s59, 0
    s_mov_b32 s10, 1409024
    s_mov_b32 s11, 0x00020000
    s_add_u32 s12, s58, 4194304
    s_addc_u32 s13, s59, 0
    s_mov_b32 s14, 1409024
    s_mov_b32 s15, 0x00020000
    s_add_u32 s16, s58, 8388608
    s_addc_u32 s17, s59, 0
    s_mov_b32 s18, 5636096
    s_mov_b32 s19, 0x00020000
    s_lshl_b32 s62, s60, 16
    v_lshlrev_b32 v3, 4, v0
    v_add_u32 v4, s62, v3
    buffer_load_dwordx4 v[8:11], v4, s[4:7], 0 offen
    v_add_u32 v4, 0x1000, v4
    buffer_load_dwordx4 v[12:15], v4, s[4:7], 0 offen
    v_add_u32 v4, 0x1000, v4
    buffer_load_dwordx4 v[16:19], v4, s[4:7], 0 offen
    v_add_u32 v4, 0x1000, v4
    buffer_load_dwordx4 v[20:23], v4, s[4:7], 0 offen
    v_add_u32 v4, 0x1000, v4
    buffer_load_dwordx4 v[24:27], v4, s[4:7], 0 offen
    v_add_u32 v4, 0x1000, v4
    buffer_load_dwordx4 v[28:31], v4, s[4:7], 0 offen
    v_add_u32 v4, 0x1000, v4
    buffer_load_dwordx4 v[32:35], v4, s[4:7], 0 offen
    v_add_u32 v4, 0x1000, v4
    buffer_load_dwordx4 v[36:39], v4, s[4:7], 0 offen
    v_add_u32 v4, 0x1000, v4
    buffer_load_dwordx4 v[40:43], v4, s[4:7], 0 offen
    v_add_u32 v4, 0x1000, v4
    buffer_load_dwordx4 v[44:47], v4, s[4:7], 0 offen
    v_add_u32 v4, 0x1000, v4
    buffer_load_dwordx4 v[48:51], v4, s[4:7], 0 offen
    v_add_u32 v4, 0x1000, v4
    buffer_load_dwordx4 v[52:55], v4, s[4:7], 0 offen
    v_add_u32 v4, 0x1000, v4
    buffer_load_dwordx4 v[56:59], v4, s[4:7], 0 offen
    v_add_u32 v4, 0x1000, v4
    buffer_load_dwordx4 v[60:63], v4, s[4:7], 0 offen
    v_add_u32 v4, 0x1000, v4
    buffer_load_dwordx4 v[64:67], v4, s[4:7], 0 offen
    v_add_u32 v4, 0x1000, v4
    buffer_load_dwordx4 v[68:71], v4, s[4:7], 0 offen
    v_add_u32 v4, 0x1000, v4
    s_waitcnt vmcnt(15)
    ds_write_b128 v3, v[8:11] offset:0
    s_waitcnt vmcnt(14)
    ds_write_b128 v3, v[12:15] offset:4096
    s_waitcnt vmcnt(13)
    ds_write_b128 v3, v[16:19] offset:8192
    s_waitcnt vmcnt(12)
    ds_write_b128 v3, v[20:23] offset:12288
    s_waitcnt vmcnt(11)
    ds_write_b128 v3, v[24:27] offset:16384
    s_waitcnt vmcnt(10)
    ds_write_b128 v3, v[28:31] offset:20480
    s_waitcnt vmcnt(9)
    ds_write_b128 v3, v[32:35] offset:24576
    s_waitcnt vmcnt(8)
    ds_write_b128 v3, v[36:39] offset:28672
    s_waitcnt vmcnt(7)
    ds_write_b128 v3, v[40:43] offset:32768
    s_waitcnt vmcnt(6)
    ds_write_b128 v3, v[44:47] offset:36864
    s_waitcnt vmcnt(5)
    ds_write_b128 v3, v[48:51] offset:40960
    s_waitcnt vmcnt(4)
    ds_write_b128 v3, v[52:55] offset:45056
    s_waitcnt vmcnt(3)
    ds_write_b128 v3, v[56:59] offset:49152
    s_waitcnt vmcnt(2)
    ds_write_b128 v3, v[60:63] offset:53248
    s_waitcnt vmcnt(1)
    ds_write_b128 v3, v[64:67] offset:57344
    s_waitcnt vmcnt(0)
    ds_write_b128 v3, v[68:71] offset:61440
    v_readfirstlane_b32 s63, v2
    s_lshl_b32 s64, s61, 2
    s_add_u32 s64, s64, s63
    s_waitcnt lgkmcnt(0)
    s_barrier
    s_cmp_ge_u32 s64, 43
    s_cbranch_scc1 L_g1_kernel_end
    s_lshl_b32 s65, s64, 15
    v_lshlrev_b32 v5, 4, v1
    v_add_u32 v4, s65, v5
    v_mov_b32 v64, 0
    v_mov_b32 v65, 0
    v_mov_b32 v66, 0
    v_mov_b32 v67, 0
    v_mov_b32 v68, 0
    v_mov_b32 v69, 0
    v_mov_b32 v70, 0
    v_mov_b32 v71, 0
    v_mov_b32 v72, 0
    v_mov_b32 v73, 0
    v_mov_b32 v74, 0
    v_mov_b32 v75, 0
    v_mov_b32 v76, 0
    v_mov_b32 v77, 0
    v_mov_b32 v78, 0
    v_mov_b32 v79, 0
    v_mov_b32 v80, 0
    v_mov_b32 v81, 0
    v_mov_b32 v82, 0
    v_mov_b32 v83, 0
    v_mov_b32 v84, 0
    v_mov_b32 v85, 0
    v_mov_b32 v86, 0
    v_mov_b32 v87, 0
    v_mov_b32 v88, 0
    v_mov_b32 v89, 0
    v_mov_b32 v90, 0
    v_mov_b32 v91, 0
    v_mov_b32 v92, 0
    v_mov_b32 v93, 0
    v_mov_b32 v94, 0
    v_mov_b32 v95, 0
    v_mov_b32 v96, 0
    v_mov_b32 v97, 0
    v_mov_b32 v98, 0
    v_mov_b32 v99, 0
    v_mov_b32 v100, 0
    v_mov_b32 v101, 0
    v_mov_b32 v102, 0
    v_mov_b32 v103, 0
    v_mov_b32 v104, 0
    v_mov_b32 v105, 0
    v_mov_b32 v106, 0
    v_mov_b32 v107, 0
    v_mov_b32 v108, 0
    v_mov_b32 v109, 0
    v_mov_b32 v110, 0
    v_mov_b32 v111, 0
    v_mov_b32 v112, 0
    v_mov_b32 v113, 0
    v_mov_b32 v114, 0
    v_mov_b32 v115, 0
    v_mov_b32 v116, 0
    v_mov_b32 v117, 0
    v_mov_b32 v118, 0
    v_mov_b32 v119, 0
    v_mov_b32 v120, 0
    v_mov_b32 v121, 0
    v_mov_b32 v122, 0
    v_mov_b32 v123, 0
    v_mov_b32 v124, 0
    v_mov_b32 v125, 0
    v_mov_b32 v126, 0
    v_mov_b32 v127, 0
    buffer_load_dwordx4 v[8:11], v4, s[8:11], 0 offen offset:0
    buffer_load_dwordx4 v[12:15], v4, s[12:15], 0 offen offset:0
    buffer_load_dwordx4 v[16:19], v4, s[8:11], 0 offen offset:1024
    buffer_load_dwordx4 v[20:23], v4, s[12:15], 0 offen offset:1024
    buffer_load_dwordx4 v[24:27], v4, s[8:11], 0 offen offset:2048
    buffer_load_dwordx4 v[28:31], v4, s[12:15], 0 offen offset:2048
    buffer_load_dwordx4 v[32:35], v4, s[8:11], 0 offen offset:3072
    buffer_load_dwordx4 v[36:39], v4, s[12:15], 0 offen offset:3072
    v_add_u32 v4, 0x1000, v4
    ds_read_b128 v[40:43], v5 offset:0
    ds_read_b128 v[44:47], v5 offset:32768
    s_waitcnt vmcnt(6) lgkmcnt(0)
    v_mfma_f32_32x32x16_bf16 v[64:79], v[8:11], v[40:43], v[64:79]
    v_mfma_f32_32x32x16_bf16 v[80:95], v[8:11], v[44:47], v[80:95]
    v_mfma_f32_32x32x16_bf16 v[96:111], v[12:15], v[40:43], v[96:111]
    v_mfma_f32_32x32x16_bf16 v[112:127], v[12:15], v[44:47], v[112:127]
    buffer_load_dwordx4 v[8:11], v4, s[8:11], 0 offen offset:0
    buffer_load_dwordx4 v[12:15], v4, s[12:15], 0 offen offset:0
    ds_read_b128 v[40:43], v5 offset:1024
    ds_read_b128 v[44:47], v5 offset:33792
    s_waitcnt vmcnt(6) lgkmcnt(0)
    v_mfma_f32_32x32x16_bf16 v[64:79], v[16:19], v[40:43], v[64:79]
    v_mfma_f32_32x32x16_bf16 v[80:95], v[16:19], v[44:47], v[80:95]
    v_mfma_f32_32x32x16_bf16 v[96:111], v[20:23], v[40:43], v[96:111]
    v_mfma_f32_32x32x16_bf16 v[112:127], v[20:23], v[44:47], v[112:127]
    buffer_load_dwordx4 v[16:19], v4, s[8:11], 0 offen offset:1024
    buffer_load_dwordx4 v[20:23], v4, s[12:15], 0 offen offset:1024
    ds_read_b128 v[40:43], v5 offset:2048
    ds_read_b128 v[44:47], v5 offset:34816
    s_waitcnt vmcnt(6) lgkmcnt(0)
    v_mfma_f32_32x32x16_bf16 v[64:79], v[24:27], v[40:43], v[64:79]
    v_mfma_f32_32x32x16_bf16 v[80:95], v[24:27], v[44:47], v[80:95]
    v_mfma_f32_32x32x16_bf16 v[96:111], v[28:31], v[40:43], v[96:111]
    v_mfma_f32_32x32x16_bf16 v[112:127], v[28:31], v[44:47], v[112:127]
    buffer_load_dwordx4 v[24:27], v4, s[8:11], 0 offen offset:2048
    buffer_load_dwordx4 v[28:31], v4, s[12:15], 0 offen offset:2048
    ds_read_b128 v[40:43], v5 offset:3072
    ds_read_b128 v[44:47], v5 offset:35840
    s_waitcnt vmcnt(6) lgkmcnt(0)
    v_mfma_f32_32x32x16_bf16 v[64:79], v[32:35], v[40:43], v[64:79]
    v_mfma_f32_32x32x16_bf16 v[80:95], v[32:35], v[44:47], v[80:95]
    v_mfma_f32_32x32x16_bf16 v[96:111], v[36:39], v[40:43], v[96:111]
    v_mfma_f32_32x32x16_bf16 v[112:127], v[36:39], v[44:47], v[112:127]
    buffer_load_dwordx4 v[32:35], v4, s[8:11], 0 offen offset:3072
    buffer_load_dwordx4 v[36:39], v4, s[12:15], 0 offen offset:3072
    v_add_u32 v4, 0x1000, v4
    ds_read_b128 v[40:43], v5 offset:4096
    ds_read_b128 v[44:47], v5 offset:36864
    s_waitcnt vmcnt(6) lgkmcnt(0)
    v_mfma_f32_32x32x16_bf16 v[64:79], v[8:11], v[40:43], v[64:79]
    v_mfma_f32_32x32x16_bf16 v[80:95], v[8:11], v[44:47], v[80:95]
    v_mfma_f32_32x32x16_bf16 v[96:111], v[12:15], v[40:43], v[96:111]
    v_mfma_f32_32x32x16_bf16 v[112:127], v[12:15], v[44:47], v[112:127]
    buffer_load_dwordx4 v[8:11], v4, s[8:11], 0 offen offset:0
    buffer_load_dwordx4 v[12:15], v4, s[12:15], 0 offen offset:0
    ds_read_b128 v[40:43], v5 offset:5120
    ds_read_b128 v[44:47], v5 offset:37888
    s_waitcnt vmcnt(6) lgkmcnt(0)
    v_mfma_f32_32x32x16_bf16 v[64:79], v[16:19], v[40:43], v[64:79]
    v_mfma_f32_32x32x16_bf16 v[80:95], v[16:19], v[44:47], v[80:95]
    v_mfma_f32_32x32x16_bf16 v[96:111], v[20:23], v[40:43], v[96:111]
    v_mfma_f32_32x32x16_bf16 v[112:127], v[20:23], v[44:47], v[112:127]
    buffer_load_dwordx4 v[16:19], v4, s[8:11], 0 offen offset:1024
    buffer_load_dwordx4 v[20:23], v4, s[12:15], 0 offen offset:1024
    ds_read_b128 v[40:43], v5 offset:6144
    ds_read_b128 v[44:47], v5 offset:38912
    s_waitcnt vmcnt(6) lgkmcnt(0)
    v_mfma_f32_32x32x16_bf16 v[64:79], v[24:27], v[40:43], v[64:79]
    v_mfma_f32_32x32x16_bf16 v[80:95], v[24:27], v[44:47], v[80:95]
    v_mfma_f32_32x32x16_bf16 v[96:111], v[28:31], v[40:43], v[96:111]
    v_mfma_f32_32x32x16_bf16 v[112:127], v[28:31], v[44:47], v[112:127]
    buffer_load_dwordx4 v[24:27], v4, s[8:11], 0 offen offset:2048
    buffer_load_dwordx4 v[28:31], v4, s[12:15], 0 offen offset:2048
    ds_read_b128 v[40:43], v5 offset:7168
    ds_read_b128 v[44:47], v5 offset:39936
    s_waitcnt vmcnt(6) lgkmcnt(0)
    v_mfma_f32_32x32x16_bf16 v[64:79], v[32:35], v[40:43], v[64:79]
    v_mfma_f32_32x32x16_bf16 v[80:95], v[32:35], v[44:47], v[80:95]
    v_mfma_f32_32x32x16_bf16 v[96:111], v[36:39], v[40:43], v[96:111]
    v_mfma_f32_32x32x16_bf16 v[112:127], v[36:39], v[44:47], v[112:127]
    buffer_load_dwordx4 v[32:35], v4, s[8:11], 0 offen offset:3072
    buffer_load_dwordx4 v[36:39], v4, s[12:15], 0 offen offset:3072
    v_add_u32 v4, 0x1000, v4
    ds_read_b128 v[40:43], v5 offset:8192
    ds_read_b128 v[44:47], v5 offset:40960
    s_waitcnt vmcnt(6) lgkmcnt(0)
    v_mfma_f32_32x32x16_bf16 v[64:79], v[8:11], v[40:43], v[64:79]
    v_mfma_f32_32x32x16_bf16 v[80:95], v[8:11], v[44:47], v[80:95]
    v_mfma_f32_32x32x16_bf16 v[96:111], v[12:15], v[40:43], v[96:111]
    v_mfma_f32_32x32x16_bf16 v[112:127], v[12:15], v[44:47], v[112:127]
    buffer_load_dwordx4 v[8:11], v4, s[8:11], 0 offen offset:0
    buffer_load_dwordx4 v[12:15], v4, s[12:15], 0 offen offset:0
    ds_read_b128 v[40:43], v5 offset:9216
    ds_read_b128 v[44:47], v5 offset:41984
    s_waitcnt vmcnt(6) lgkmcnt(0)
    v_mfma_f32_32x32x16_bf16 v[64:79], v[16:19], v[40:43], v[64:79]
    v_mfma_f32_32x32x16_bf16 v[80:95], v[16:19], v[44:47], v[80:95]
    v_mfma_f32_32x32x16_bf16 v[96:111], v[20:23], v[40:43], v[96:111]
    v_mfma_f32_32x32x16_bf16 v[112:127], v[20:23], v[44:47], v[112:127]
    buffer_load_dwordx4 v[16:19], v4, s[8:11], 0 offen offset:1024
    buffer_load_dwordx4 v[20:23], v4, s[12:15], 0 offen offset:1024
    ds_read_b128 v[40:43], v5 offset:10240
    ds_read_b128 v[44:47], v5 offset:43008
    s_waitcnt vmcnt(6) lgkmcnt(0)
    v_mfma_f32_32x32x16_bf16 v[64:79], v[24:27], v[40:43], v[64:79]
    v_mfma_f32_32x32x16_bf16 v[80:95], v[24:27], v[44:47], v[80:95]
    v_mfma_f32_32x32x16_bf16 v[96:111], v[28:31], v[40:43], v[96:111]
    v_mfma_f32_32x32x16_bf16 v[112:127], v[28:31], v[44:47], v[112:127]
    buffer_load_dwordx4 v[24:27], v4, s[8:11], 0 offen offset:2048
    buffer_load_dwordx4 v[28:31], v4, s[12:15], 0 offen offset:2048
    ds_read_b128 v[40:43], v5 offset:11264
    ds_read_b128 v[44:47], v5 offset:44032
    s_waitcnt vmcnt(6) lgkmcnt(0)
    v_mfma_f32_32x32x16_bf16 v[64:79], v[32:35], v[40:43], v[64:79]
    v_mfma_f32_32x32x16_bf16 v[80:95], v[32:35], v[44:47], v[80:95]
    v_mfma_f32_32x32x16_bf16 v[96:111], v[36:39], v[40:43], v[96:111]
    v_mfma_f32_32x32x16_bf16 v[112:127], v[36:39], v[44:47], v[112:127]
    buffer_load_dwordx4 v[32:35], v4, s[8:11], 0 offen offset:3072
    buffer_load_dwordx4 v[36:39], v4, s[12:15], 0 offen offset:3072
    v_add_u32 v4, 0x1000, v4
    ds_read_b128 v[40:43], v5 offset:12288
    ds_read_b128 v[44:47], v5 offset:45056
    s_waitcnt vmcnt(6) lgkmcnt(0)
    v_mfma_f32_32x32x16_bf16 v[64:79], v[8:11], v[40:43], v[64:79]
    v_mfma_f32_32x32x16_bf16 v[80:95], v[8:11], v[44:47], v[80:95]
    v_mfma_f32_32x32x16_bf16 v[96:111], v[12:15], v[40:43], v[96:111]
    v_mfma_f32_32x32x16_bf16 v[112:127], v[12:15], v[44:47], v[112:127]
    buffer_load_dwordx4 v[8:11], v4, s[8:11], 0 offen offset:0
    buffer_load_dwordx4 v[12:15], v4, s[12:15], 0 offen offset:0
    ds_read_b128 v[40:43], v5 offset:13312
    ds_read_b128 v[44:47], v5 offset:46080
    s_waitcnt vmcnt(6) lgkmcnt(0)
    v_mfma_f32_32x32x16_bf16 v[64:79], v[16:19], v[40:43], v[64:79]
    v_mfma_f32_32x32x16_bf16 v[80:95], v[16:19], v[44:47], v[80:95]
    v_mfma_f32_32x32x16_bf16 v[96:111], v[20:23], v[40:43], v[96:111]
    v_mfma_f32_32x32x16_bf16 v[112:127], v[20:23], v[44:47], v[112:127]
    buffer_load_dwordx4 v[16:19], v4, s[8:11], 0 offen offset:1024
    buffer_load_dwordx4 v[20:23], v4, s[12:15], 0 offen offset:1024
    ds_read_b128 v[40:43], v5 offset:14336
    ds_read_b128 v[44:47], v5 offset:47104
    s_waitcnt vmcnt(6) lgkmcnt(0)
    v_mfma_f32_32x32x16_bf16 v[64:79], v[24:27], v[40:43], v[64:79]
    v_mfma_f32_32x32x16_bf16 v[80:95], v[24:27], v[44:47], v[80:95]
    v_mfma_f32_32x32x16_bf16 v[96:111], v[28:31], v[40:43], v[96:111]
    v_mfma_f32_32x32x16_bf16 v[112:127], v[28:31], v[44:47], v[112:127]
    buffer_load_dwordx4 v[24:27], v4, s[8:11], 0 offen offset:2048
    buffer_load_dwordx4 v[28:31], v4, s[12:15], 0 offen offset:2048
    ds_read_b128 v[40:43], v5 offset:15360
    ds_read_b128 v[44:47], v5 offset:48128
    s_waitcnt vmcnt(6) lgkmcnt(0)
    v_mfma_f32_32x32x16_bf16 v[64:79], v[32:35], v[40:43], v[64:79]
    v_mfma_f32_32x32x16_bf16 v[80:95], v[32:35], v[44:47], v[80:95]
    v_mfma_f32_32x32x16_bf16 v[96:111], v[36:39], v[40:43], v[96:111]
    v_mfma_f32_32x32x16_bf16 v[112:127], v[36:39], v[44:47], v[112:127]
    buffer_load_dwordx4 v[32:35], v4, s[8:11], 0 offen offset:3072
    buffer_load_dwordx4 v[36:39], v4, s[12:15], 0 offen offset:3072
    v_add_u32 v4, 0x1000, v4
    ds_read_b128 v[40:43], v5 offset:16384
    ds_read_b128 v[44:47], v5 offset:49152
    s_waitcnt vmcnt(6) lgkmcnt(0)
    v_mfma_f32_32x32x16_bf16 v[64:79], v[8:11], v[40:43], v[64:79]
    v_mfma_f32_32x32x16_bf16 v[80:95], v[8:11], v[44:47], v[80:95]
    v_mfma_f32_32x32x16_bf16 v[96:111], v[12:15], v[40:43], v[96:111]
    v_mfma_f32_32x32x16_bf16 v[112:127], v[12:15], v[44:47], v[112:127]
    buffer_load_dwordx4 v[8:11], v4, s[8:11], 0 offen offset:0
    buffer_load_dwordx4 v[12:15], v4, s[12:15], 0 offen offset:0
    ds_read_b128 v[40:43], v5 offset:17408
    ds_read_b128 v[44:47], v5 offset:50176
    s_waitcnt vmcnt(6) lgkmcnt(0)
    v_mfma_f32_32x32x16_bf16 v[64:79], v[16:19], v[40:43], v[64:79]
    v_mfma_f32_32x32x16_bf16 v[80:95], v[16:19], v[44:47], v[80:95]
    v_mfma_f32_32x32x16_bf16 v[96:111], v[20:23], v[40:43], v[96:111]
    v_mfma_f32_32x32x16_bf16 v[112:127], v[20:23], v[44:47], v[112:127]
    buffer_load_dwordx4 v[16:19], v4, s[8:11], 0 offen offset:1024
    buffer_load_dwordx4 v[20:23], v4, s[12:15], 0 offen offset:1024
    ds_read_b128 v[40:43], v5 offset:18432
    ds_read_b128 v[44:47], v5 offset:51200
    s_waitcnt vmcnt(6) lgkmcnt(0)
    v_mfma_f32_32x32x16_bf16 v[64:79], v[24:27], v[40:43], v[64:79]
    v_mfma_f32_32x32x16_bf16 v[80:95], v[24:27], v[44:47], v[80:95]
    v_mfma_f32_32x32x16_bf16 v[96:111], v[28:31], v[40:43], v[96:111]
    v_mfma_f32_32x32x16_bf16 v[112:127], v[28:31], v[44:47], v[112:127]
    buffer_load_dwordx4 v[24:27], v4, s[8:11], 0 offen offset:2048
    buffer_load_dwordx4 v[28:31], v4, s[12:15], 0 offen offset:2048
    ds_read_b128 v[40:43], v5 offset:19456
    ds_read_b128 v[44:47], v5 offset:52224
    s_waitcnt vmcnt(6) lgkmcnt(0)
    v_mfma_f32_32x32x16_bf16 v[64:79], v[32:35], v[40:43], v[64:79]
    v_mfma_f32_32x32x16_bf16 v[80:95], v[32:35], v[44:47], v[80:95]
    v_mfma_f32_32x32x16_bf16 v[96:111], v[36:39], v[40:43], v[96:111]
    v_mfma_f32_32x32x16_bf16 v[112:127], v[36:39], v[44:47], v[112:127]
    buffer_load_dwordx4 v[32:35], v4, s[8:11], 0 offen offset:3072
    buffer_load_dwordx4 v[36:39], v4, s[12:15], 0 offen offset:3072
    v_add_u32 v4, 0x1000, v4
    ds_read_b128 v[40:43], v5 offset:20480
    ds_read_b128 v[44:47], v5 offset:53248
    s_waitcnt vmcnt(6) lgkmcnt(0)
    v_mfma_f32_32x32x16_bf16 v[64:79], v[8:11], v[40:43], v[64:79]
    v_mfma_f32_32x32x16_bf16 v[80:95], v[8:11], v[44:47], v[80:95]
    v_mfma_f32_32x32x16_bf16 v[96:111], v[12:15], v[40:43], v[96:111]
    v_mfma_f32_32x32x16_bf16 v[112:127], v[12:15], v[44:47], v[112:127]
    buffer_load_dwordx4 v[8:11], v4, s[8:11], 0 offen offset:0
    buffer_load_dwordx4 v[12:15], v4, s[12:15], 0 offen offset:0
    ds_read_b128 v[40:43], v5 offset:21504
    ds_read_b128 v[44:47], v5 offset:54272
    s_waitcnt vmcnt(6) lgkmcnt(0)
    v_mfma_f32_32x32x16_bf16 v[64:79], v[16:19], v[40:43], v[64:79]
    v_mfma_f32_32x32x16_bf16 v[80:95], v[16:19], v[44:47], v[80:95]
    v_mfma_f32_32x32x16_bf16 v[96:111], v[20:23], v[40:43], v[96:111]
    v_mfma_f32_32x32x16_bf16 v[112:127], v[20:23], v[44:47], v[112:127]
    buffer_load_dwordx4 v[16:19], v4, s[8:11], 0 offen offset:1024
    buffer_load_dwordx4 v[20:23], v4, s[12:15], 0 offen offset:1024
    ds_read_b128 v[40:43], v5 offset:22528
    ds_read_b128 v[44:47], v5 offset:55296
    s_waitcnt vmcnt(6) lgkmcnt(0)
    v_mfma_f32_32x32x16_bf16 v[64:79], v[24:27], v[40:43], v[64:79]
    v_mfma_f32_32x32x16_bf16 v[80:95], v[24:27], v[44:47], v[80:95]
    v_mfma_f32_32x32x16_bf16 v[96:111], v[28:31], v[40:43], v[96:111]
    v_mfma_f32_32x32x16_bf16 v[112:127], v[28:31], v[44:47], v[112:127]
    buffer_load_dwordx4 v[24:27], v4, s[8:11], 0 offen offset:2048
    buffer_load_dwordx4 v[28:31], v4, s[12:15], 0 offen offset:2048
    ds_read_b128 v[40:43], v5 offset:23552
    ds_read_b128 v[44:47], v5 offset:56320
    s_waitcnt vmcnt(6) lgkmcnt(0)
    v_mfma_f32_32x32x16_bf16 v[64:79], v[32:35], v[40:43], v[64:79]
    v_mfma_f32_32x32x16_bf16 v[80:95], v[32:35], v[44:47], v[80:95]
    v_mfma_f32_32x32x16_bf16 v[96:111], v[36:39], v[40:43], v[96:111]
    v_mfma_f32_32x32x16_bf16 v[112:127], v[36:39], v[44:47], v[112:127]
    buffer_load_dwordx4 v[32:35], v4, s[8:11], 0 offen offset:3072
    buffer_load_dwordx4 v[36:39], v4, s[12:15], 0 offen offset:3072
    v_add_u32 v4, 0x1000, v4
    ds_read_b128 v[40:43], v5 offset:24576
    ds_read_b128 v[44:47], v5 offset:57344
    s_waitcnt vmcnt(6) lgkmcnt(0)
    v_mfma_f32_32x32x16_bf16 v[64:79], v[8:11], v[40:43], v[64:79]
    v_mfma_f32_32x32x16_bf16 v[80:95], v[8:11], v[44:47], v[80:95]
    v_mfma_f32_32x32x16_bf16 v[96:111], v[12:15], v[40:43], v[96:111]
    v_mfma_f32_32x32x16_bf16 v[112:127], v[12:15], v[44:47], v[112:127]
    buffer_load_dwordx4 v[8:11], v4, s[8:11], 0 offen offset:0
    buffer_load_dwordx4 v[12:15], v4, s[12:15], 0 offen offset:0
    ds_read_b128 v[40:43], v5 offset:25600
    ds_read_b128 v[44:47], v5 offset:58368
    s_waitcnt vmcnt(6) lgkmcnt(0)
    v_mfma_f32_32x32x16_bf16 v[64:79], v[16:19], v[40:43], v[64:79]
    v_mfma_f32_32x32x16_bf16 v[80:95], v[16:19], v[44:47], v[80:95]
    v_mfma_f32_32x32x16_bf16 v[96:111], v[20:23], v[40:43], v[96:111]
    v_mfma_f32_32x32x16_bf16 v[112:127], v[20:23], v[44:47], v[112:127]
    buffer_load_dwordx4 v[16:19], v4, s[8:11], 0 offen offset:1024
    buffer_load_dwordx4 v[20:23], v4, s[12:15], 0 offen offset:1024
    ds_read_b128 v[40:43], v5 offset:26624
    ds_read_b128 v[44:47], v5 offset:59392
    s_waitcnt vmcnt(6) lgkmcnt(0)
    v_mfma_f32_32x32x16_bf16 v[64:79], v[24:27], v[40:43], v[64:79]
    v_mfma_f32_32x32x16_bf16 v[80:95], v[24:27], v[44:47], v[80:95]
    v_mfma_f32_32x32x16_bf16 v[96:111], v[28:31], v[40:43], v[96:111]
    v_mfma_f32_32x32x16_bf16 v[112:127], v[28:31], v[44:47], v[112:127]
    buffer_load_dwordx4 v[24:27], v4, s[8:11], 0 offen offset:2048
    buffer_load_dwordx4 v[28:31], v4, s[12:15], 0 offen offset:2048
    ds_read_b128 v[40:43], v5 offset:27648
    ds_read_b128 v[44:47], v5 offset:60416
    s_waitcnt vmcnt(6) lgkmcnt(0)
    v_mfma_f32_32x32x16_bf16 v[64:79], v[32:35], v[40:43], v[64:79]
    v_mfma_f32_32x32x16_bf16 v[80:95], v[32:35], v[44:47], v[80:95]
    v_mfma_f32_32x32x16_bf16 v[96:111], v[36:39], v[40:43], v[96:111]
    v_mfma_f32_32x32x16_bf16 v[112:127], v[36:39], v[44:47], v[112:127]
    buffer_load_dwordx4 v[32:35], v4, s[8:11], 0 offen offset:3072
    buffer_load_dwordx4 v[36:39], v4, s[12:15], 0 offen offset:3072
    v_add_u32 v4, 0x1000, v4
    ds_read_b128 v[40:43], v5 offset:28672
    ds_read_b128 v[44:47], v5 offset:61440
    s_waitcnt vmcnt(6) lgkmcnt(0)
    v_mfma_f32_32x32x16_bf16 v[64:79], v[8:11], v[40:43], v[64:79]
    v_mfma_f32_32x32x16_bf16 v[80:95], v[8:11], v[44:47], v[80:95]
    v_mfma_f32_32x32x16_bf16 v[96:111], v[12:15], v[40:43], v[96:111]
    v_mfma_f32_32x32x16_bf16 v[112:127], v[12:15], v[44:47], v[112:127]
    ds_read_b128 v[40:43], v5 offset:29696
    ds_read_b128 v[44:47], v5 offset:62464
    s_waitcnt vmcnt(4) lgkmcnt(0)
    v_mfma_f32_32x32x16_bf16 v[64:79], v[16:19], v[40:43], v[64:79]
    v_mfma_f32_32x32x16_bf16 v[80:95], v[16:19], v[44:47], v[80:95]
    v_mfma_f32_32x32x16_bf16 v[96:111], v[20:23], v[40:43], v[96:111]
    v_mfma_f32_32x32x16_bf16 v[112:127], v[20:23], v[44:47], v[112:127]
    ds_read_b128 v[40:43], v5 offset:30720
    ds_read_b128 v[44:47], v5 offset:63488
    s_waitcnt vmcnt(2) lgkmcnt(0)
    v_mfma_f32_32x32x16_bf16 v[64:79], v[24:27], v[40:43], v[64:79]
    v_mfma_f32_32x32x16_bf16 v[80:95], v[24:27], v[44:47], v[80:95]
    v_mfma_f32_32x32x16_bf16 v[96:111], v[28:31], v[40:43], v[96:111]
    v_mfma_f32_32x32x16_bf16 v[112:127], v[28:31], v[44:47], v[112:127]
    ds_read_b128 v[40:43], v5 offset:31744
    ds_read_b128 v[44:47], v5 offset:64512
    s_waitcnt vmcnt(0) lgkmcnt(0)
    v_mfma_f32_32x32x16_bf16 v[64:79], v[32:35], v[40:43], v[64:79]
    v_mfma_f32_32x32x16_bf16 v[80:95], v[32:35], v[44:47], v[80:95]
    v_mfma_f32_32x32x16_bf16 v[96:111], v[36:39], v[40:43], v[96:111]
    v_mfma_f32_32x32x16_bf16 v[112:127], v[36:39], v[44:47], v[112:127]
    s_nop 15
    s_lshl_b32 s65, s60, 1
    s_mul_i32 s65, s65, 86
    s_lshl_b32 s66, s64, 1
    s_add_u32 s65, s65, s66
    s_lshl_b32 s65, s65, 10
    v_add_u32 v4, s65, v5
    s_mov_b32 s66, 0xbfb8aa3b
    v_cvt_pk_bf16_f32 v40, v64, v65
    v_cvt_pk_bf16_f32 v41, v96, v97
    v_lshlrev_b32 v42, 16, v40
    v_and_b32 v43, 0xffff0000, v40
    v_mul_f32 v44, s66, v42
    v_mul_f32 v45, s66, v43
    v_exp_f32 v44, v44
    v_exp_f32 v45, v45
    s_nop 0
    v_add_f32 v44, 1.0, v44
    v_add_f32 v45, 1.0, v45
    v_rcp_f32 v44, v44
    v_rcp_f32 v45, v45
    s_nop 0
    v_mul_f32 v42, v42, v44
    v_mul_f32 v43, v43, v45
    v_cvt_pk_bf16_f32 v40, v42, v43
    v_lshlrev_b32 v42, 16, v40
    v_and_b32 v43, 0xffff0000, v40
    v_lshlrev_b32 v44, 16, v41
    v_and_b32 v45, 0xffff0000, v41
    v_mul_f32 v42, v42, v44
    v_mul_f32 v43, v43, v45
    v_cvt_pk_bf16_f32 v48, v42, v43
    v_cvt_pk_bf16_f32 v40, v66, v67
    v_cvt_pk_bf16_f32 v41, v98, v99
    v_lshlrev_b32 v42, 16, v40
    v_and_b32 v43, 0xffff0000, v40
    v_mul_f32 v44, s66, v42
    v_mul_f32 v45, s66, v43
    v_exp_f32 v44, v44
    v_exp_f32 v45, v45
    s_nop 0
    v_add_f32 v44, 1.0, v44
    v_add_f32 v45, 1.0, v45
    v_rcp_f32 v44, v44
    v_rcp_f32 v45, v45
    s_nop 0
    v_mul_f32 v42, v42, v44
    v_mul_f32 v43, v43, v45
    v_cvt_pk_bf16_f32 v40, v42, v43
    v_lshlrev_b32 v42, 16, v40
    v_and_b32 v43, 0xffff0000, v40
    v_lshlrev_b32 v44, 16, v41
    v_and_b32 v45, 0xffff0000, v41
    v_mul_f32 v42, v42, v44
    v_mul_f32 v43, v43, v45
    v_cvt_pk_bf16_f32 v49, v42, v43
    v_cvt_pk_bf16_f32 v40, v68, v69
    v_cvt_pk_bf16_f32 v41, v100, v101
    v_lshlrev_b32 v42, 16, v40
    v_and_b32 v43, 0xffff0000, v40
    v_mul_f32 v44, s66, v42
    v_mul_f32 v45, s66, v43
    v_exp_f32 v44, v44
    v_exp_f32 v45, v45
    s_nop 0
    v_add_f32 v44, 1.0, v44
    v_add_f32 v45, 1.0, v45
    v_rcp_f32 v44, v44
    v_rcp_f32 v45, v45
    s_nop 0
    v_mul_f32 v42, v42, v44
    v_mul_f32 v43, v43, v45
    v_cvt_pk_bf16_f32 v40, v42, v43
    v_lshlrev_b32 v42, 16, v40
    v_and_b32 v43, 0xffff0000, v40
    v_lshlrev_b32 v44, 16, v41
    v_and_b32 v45, 0xffff0000, v41
    v_mul_f32 v42, v42, v44
    v_mul_f32 v43, v43, v45
    v_cvt_pk_bf16_f32 v50, v42, v43
    v_cvt_pk_bf16_f32 v40, v70, v71
    v_cvt_pk_bf16_f32 v41, v102, v103
    v_lshlrev_b32 v42, 16, v40
    v_and_b32 v43, 0xffff0000, v40
    v_mul_f32 v44, s66, v42
    v_mul_f32 v45, s66, v43
    v_exp_f32 v44, v44
    v_exp_f32 v45, v45
    s_nop 0
    v_add_f32 v44, 1.0, v44
    v_add_f32 v45, 1.0, v45
    v_rcp_f32 v44, v44
    v_rcp_f32 v45, v45
    s_nop 0
    v_mul_f32 v42, v42, v44
    v_mul_f32 v43, v43, v45
    v_cvt_pk_bf16_f32 v40, v42, v43
    v_lshlrev_b32 v42, 16, v40
    v_and_b32 v43, 0xffff0000, v40
    v_lshlrev_b32 v44, 16, v41
    v_and_b32 v45, 0xffff0000, v41
    v_mul_f32 v42, v42, v44
    v_mul_f32 v43, v43, v45
    v_cvt_pk_bf16_f32 v51, v42, v43
    buffer_store_dwordx4 v[48:51], v4, s[16:19], 0 offen offset:0
    s_nop 1
    v_cvt_pk_bf16_f32 v40, v72, v73
    v_cvt_pk_bf16_f32 v41, v104, v105
    v_lshlrev_b32 v42, 16, v40
    v_and_b32 v43, 0xffff0000, v40
    v_mul_f32 v44, s66, v42
    v_mul_f32 v45, s66, v43
    v_exp_f32 v44, v44
    v_exp_f32 v45, v45
    s_nop 0
    v_add_f32 v44, 1.0, v44
    v_add_f32 v45, 1.0, v45
    v_rcp_f32 v44, v44
    v_rcp_f32 v45, v45
    s_nop 0
    v_mul_f32 v42, v42, v44
    v_mul_f32 v43, v43, v45
    v_cvt_pk_bf16_f32 v40, v42, v43
    v_lshlrev_b32 v42, 16, v40
    v_and_b32 v43, 0xffff0000, v40
    v_lshlrev_b32 v44, 16, v41
    v_and_b32 v45, 0xffff0000, v41
    v_mul_f32 v42, v42, v44
    v_mul_f32 v43, v43, v45
    v_cvt_pk_bf16_f32 v48, v42, v43
    v_cvt_pk_bf16_f32 v40, v74, v75
    v_cvt_pk_bf16_f32 v41, v106, v107
    v_lshlrev_b32 v42, 16, v40
    v_and_b32 v43, 0xffff0000, v40
    v_mul_f32 v44, s66, v42
    v_mul_f32 v45, s66, v43
    v_exp_f32 v44, v44
    v_exp_f32 v45, v45
    s_nop 0
    v_add_f32 v44, 1.0, v44
    v_add_f32 v45, 1.0, v45
    v_rcp_f32 v44, v44
    v_rcp_f32 v45, v45
    s_nop 0
    v_mul_f32 v42, v42, v44
    v_mul_f32 v43, v43, v45
    v_cvt_pk_bf16_f32 v40, v42, v43
    v_lshlrev_b32 v42, 16, v40
    v_and_b32 v43, 0xffff0000, v40
    v_lshlrev_b32 v44, 16, v41
    v_and_b32 v45, 0xffff0000, v41
    v_mul_f32 v42, v42, v44
    v_mul_f32 v43, v43, v45
    v_cvt_pk_bf16_f32 v49, v42, v43
    v_cvt_pk_bf16_f32 v40, v76, v77
    v_cvt_pk_bf16_f32 v41, v108, v109
    v_lshlrev_b32 v42, 16, v40
    v_and_b32 v43, 0xffff0000, v40
    v_mul_f32 v44, s66, v42
    v_mul_f32 v45, s66, v43
    v_exp_f32 v44, v44
    v_exp_f32 v45, v45
    s_nop 0
    v_add_f32 v44, 1.0, v44
    v_add_f32 v45, 1.0, v45
    v_rcp_f32 v44, v44
    v_rcp_f32 v45, v45
    s_nop 0
    v_mul_f32 v42, v42, v44
    v_mul_f32 v43, v43, v45
    v_cvt_pk_bf16_f32 v40, v42, v43
    v_lshlrev_b32 v42, 16, v40
    v_and_b32 v43, 0xffff0000, v40
    v_lshlrev_b32 v44, 16, v41
    v_and_b32 v45, 0xffff0000, v41
    v_mul_f32 v42, v42, v44
    v_mul_f32 v43, v43, v45
    v_cvt_pk_bf16_f32 v50, v42, v43
    v_cvt_pk_bf16_f32 v40, v78, v79
    v_cvt_pk_bf16_f32 v41, v110, v111
    v_lshlrev_b32 v42, 16, v40
    v_and_b32 v43, 0xffff0000, v40
    v_mul_f32 v44, s66, v42
    v_mul_f32 v45, s66, v43
    v_exp_f32 v44, v44
    v_exp_f32 v45, v45
    s_nop 0
    v_add_f32 v44, 1.0, v44
    v_add_f32 v45, 1.0, v45
    v_rcp_f32 v44, v44
    v_rcp_f32 v45, v45
    s_nop 0
    v_mul_f32 v42, v42, v44
    v_mul_f32 v43, v43, v45
    v_cvt_pk_bf16_f32 v40, v42, v43
    v_lshlrev_b32 v42, 16, v40
    v_and_b32 v43, 0xffff0000, v40
    v_lshlrev_b32 v44, 16, v41
    v_and_b32 v45, 0xffff0000, v41
    v_mul_f32 v42, v42, v44
    v_mul_f32 v43, v43, v45
    v_cvt_pk_bf16_f32 v51, v42, v43
    buffer_store_dwordx4 v[48:51], v4, s[16:19], 0 offen offset:1024
    s_nop 1
    v_add_u32 v4, 88064, v4
    v_cvt_pk_bf16_f32 v40, v80, v81
    v_cvt_pk_bf16_f32 v41, v112, v113
    v_lshlrev_b32 v42, 16, v40
    v_and_b32 v43, 0xffff0000, v40
    v_mul_f32 v44, s66, v42
    v_mul_f32 v45, s66, v43
    v_exp_f32 v44, v44
    v_exp_f32 v45, v45
    s_nop 0
    v_add_f32 v44, 1.0, v44
    v_add_f32 v45, 1.0, v45
    v_rcp_f32 v44, v44
    v_rcp_f32 v45, v45
    s_nop 0
    v_mul_f32 v42, v42, v44
    v_mul_f32 v43, v43, v45
    v_cvt_pk_bf16_f32 v40, v42, v43
    v_lshlrev_b32 v42, 16, v40
    v_and_b32 v43, 0xffff0000, v40
    v_lshlrev_b32 v44, 16, v41
    v_and_b32 v45, 0xffff0000, v41
    v_mul_f32 v42, v42, v44
    v_mul_f32 v43, v43, v45
    v_cvt_pk_bf16_f32 v48, v42, v43
    v_cvt_pk_bf16_f32 v40, v82, v83
    v_cvt_pk_bf16_f32 v41, v114, v115
    v_lshlrev_b32 v42, 16, v40
    v_and_b32 v43, 0xffff0000, v40
    v_mul_f32 v44, s66, v42
    v_mul_f32 v45, s66, v43
    v_exp_f32 v44, v44
    v_exp_f32 v45, v45
    s_nop 0
    v_add_f32 v44, 1.0, v44
    v_add_f32 v45, 1.0, v45
    v_rcp_f32 v44, v44
    v_rcp_f32 v45, v45
    s_nop 0
    v_mul_f32 v42, v42, v44
    v_mul_f32 v43, v43, v45
    v_cvt_pk_bf16_f32 v40, v42, v43
    v_lshlrev_b32 v42, 16, v40
    v_and_b32 v43, 0xffff0000, v40
    v_lshlrev_b32 v44, 16, v41
    v_and_b32 v45, 0xffff0000, v41
    v_mul_f32 v42, v42, v44
    v_mul_f32 v43, v43, v45
    v_cvt_pk_bf16_f32 v49, v42, v43
    v_cvt_pk_bf16_f32 v40, v84, v85
    v_cvt_pk_bf16_f32 v41, v116, v117
    v_lshlrev_b32 v42, 16, v40
    v_and_b32 v43, 0xffff0000, v40
    v_mul_f32 v44, s66, v42
    v_mul_f32 v45, s66, v43
    v_exp_f32 v44, v44
    v_exp_f32 v45, v45
    s_nop 0
    v_add_f32 v44, 1.0, v44
    v_add_f32 v45, 1.0, v45
    v_rcp_f32 v44, v44
    v_rcp_f32 v45, v45
    s_nop 0
    v_mul_f32 v42, v42, v44
    v_mul_f32 v43, v43, v45
    v_cvt_pk_bf16_f32 v40, v42, v43
    v_lshlrev_b32 v42, 16, v40
    v_and_b32 v43, 0xffff0000, v40
    v_lshlrev_b32 v44, 16, v41
    v_and_b32 v45, 0xffff0000, v41
    v_mul_f32 v42, v42, v44
    v_mul_f32 v43, v43, v45
    v_cvt_pk_bf16_f32 v50, v42, v43
    v_cvt_pk_bf16_f32 v40, v86, v87
    v_cvt_pk_bf16_f32 v41, v118, v119
    v_lshlrev_b32 v42, 16, v40
    v_and_b32 v43, 0xffff0000, v40
    v_mul_f32 v44, s66, v42
    v_mul_f32 v45, s66, v43
    v_exp_f32 v44, v44
    v_exp_f32 v45, v45
    s_nop 0
    v_add_f32 v44, 1.0, v44
    v_add_f32 v45, 1.0, v45
    v_rcp_f32 v44, v44
    v_rcp_f32 v45, v45
    s_nop 0
    v_mul_f32 v42, v42, v44
    v_mul_f32 v43, v43, v45
    v_cvt_pk_bf16_f32 v40, v42, v43
    v_lshlrev_b32 v42, 16, v40
    v_and_b32 v43, 0xffff0000, v40
    v_lshlrev_b32 v44, 16, v41
    v_and_b32 v45, 0xffff0000, v41
    v_mul_f32 v42, v42, v44
    v_mul_f32 v43, v43, v45
    v_cvt_pk_bf16_f32 v51, v42, v43
    buffer_store_dwordx4 v[48:51], v4, s[16:19], 0 offen offset:0
    s_nop 1
    v_cvt_pk_bf16_f32 v40, v88, v89
    v_cvt_pk_bf16_f32 v41, v120, v121
    v_lshlrev_b32 v42, 16, v40
    v_and_b32 v43, 0xffff0000, v40
    v_mul_f32 v44, s66, v42
    v_mul_f32 v45, s66, v43
    v_exp_f32 v44, v44
    v_exp_f32 v45, v45
    s_nop 0
    v_add_f32 v44, 1.0, v44
    v_add_f32 v45, 1.0, v45
    v_rcp_f32 v44, v44
    v_rcp_f32 v45, v45
    s_nop 0
    v_mul_f32 v42, v42, v44
    v_mul_f32 v43, v43, v45
    v_cvt_pk_bf16_f32 v40, v42, v43
    v_lshlrev_b32 v42, 16, v40
    v_and_b32 v43, 0xffff0000, v40
    v_lshlrev_b32 v44, 16, v41
    v_and_b32 v45, 0xffff0000, v41
    v_mul_f32 v42, v42, v44
    v_mul_f32 v43, v43, v45
    v_cvt_pk_bf16_f32 v48, v42, v43
    v_cvt_pk_bf16_f32 v40, v90, v91
    v_cvt_pk_bf16_f32 v41, v122, v123
    v_lshlrev_b32 v42, 16, v40
    v_and_b32 v43, 0xffff0000, v40
    v_mul_f32 v44, s66, v42
    v_mul_f32 v45, s66, v43
    v_exp_f32 v44, v44
    v_exp_f32 v45, v45
    s_nop 0
    v_add_f32 v44, 1.0, v44
    v_add_f32 v45, 1.0, v45
    v_rcp_f32 v44, v44
    v_rcp_f32 v45, v45
    s_nop 0
    v_mul_f32 v42, v42, v44
    v_mul_f32 v43, v43, v45
    v_cvt_pk_bf16_f32 v40, v42, v43
    v_lshlrev_b32 v42, 16, v40
    v_and_b32 v43, 0xffff0000, v40
    v_lshlrev_b32 v44, 16, v41
    v_and_b32 v45, 0xffff0000, v41
    v_mul_f32 v42, v42, v44
    v_mul_f32 v43, v43, v45
    v_cvt_pk_bf16_f32 v49, v42, v43
    v_cvt_pk_bf16_f32 v40, v92, v93
    v_cvt_pk_bf16_f32 v41, v124, v125
    v_lshlrev_b32 v42, 16, v40
    v_and_b32 v43, 0xffff0000, v40
    v_mul_f32 v44, s66, v42
    v_mul_f32 v45, s66, v43
    v_exp_f32 v44, v44
    v_exp_f32 v45, v45
    s_nop 0
    v_add_f32 v44, 1.0, v44
    v_add_f32 v45, 1.0, v45
    v_rcp_f32 v44, v44
    v_rcp_f32 v45, v45
    s_nop 0
    v_mul_f32 v42, v42, v44
    v_mul_f32 v43, v43, v45
    v_cvt_pk_bf16_f32 v40, v42, v43
    v_lshlrev_b32 v42, 16, v40
    v_and_b32 v43, 0xffff0000, v40
    v_lshlrev_b32 v44, 16, v41
    v_and_b32 v45, 0xffff0000, v41
    v_mul_f32 v42, v42, v44
    v_mul_f32 v43, v43, v45
    v_cvt_pk_bf16_f32 v50, v42, v43
    v_cvt_pk_bf16_f32 v40, v94, v95
    v_cvt_pk_bf16_f32 v41, v126, v127
    v_lshlrev_b32 v42, 16, v40
    v_and_b32 v43, 0xffff0000, v40
    v_mul_f32 v44, s66, v42
    v_mul_f32 v45, s66, v43
    v_exp_f32 v44, v44
    v_exp_f32 v45, v45
    s_nop 0
    v_add_f32 v44, 1.0, v44
    v_add_f32 v45, 1.0, v45
    v_rcp_f32 v44, v44
    v_rcp_f32 v45, v45
    s_nop 0
    v_mul_f32 v42, v42, v44
    v_mul_f32 v43, v43, v45
    v_cvt_pk_bf16_f32 v40, v42, v43
    v_lshlrev_b32 v42, 16, v40
    v_and_b32 v43, 0xffff0000, v40
    v_lshlrev_b32 v44, 16, v41
    v_and_b32 v45, 0xffff0000, v41
    v_mul_f32 v42, v42, v44
    v_mul_f32 v43, v43, v45
    v_cvt_pk_bf16_f32 v51, v42, v43
    buffer_store_dwordx4 v[48:51], v4, s[16:19], 0 offen offset:1024
    s_nop 1
L_g1_kernel_end:
    s_endpgm
.globl g2a_kernel
.p2align 8
.type g2a_kernel,@function
g2a_kernel:
    s_load_dwordx2 s[40:41], s[0:1], 80
    s_load_dwordx2 s[58:59], s[0:1], 96
    s_cmp_ge_u32 s2, 256
    s_cbranch_scc1 L_g2a_kernel_end
    v_and_b32 v1, 63, v0
    v_lshrrev_b32 v2, 6, v0
    s_waitcnt lgkmcnt(0)
    s_add_u32 s4, s58, 6291456
    s_addc_u32 s5, s59, 0
    s_mov_b32 s6, 1409024
    s_mov_b32 s7, 0x00020000
    s_add_u32 s8, s58, 8388608
    s_addc_u32 s9, s59, 0
    s_mov_b32 s10, 5636096
    s_mov_b32 s11, 0x00020000
    s_add_u32 s12, s58, 16777216
    s_addc_u32 s13, s59, 0
    s_mov_b32 s14, 2097152
    s_mov_b32 s15, 0x00020000
    s_add_u32 s16, s58, 18874368
    s_addc_u32 s17, s59, 0
    s_mov_b32 s18, 2097152
    s_mov_b32 s19, 0x00020000
    v_readfirstlane_b32 s63, v2
    s_and_b32 s60, s2, 31
    s_lshl_b32 s60, s60, 1
    s_and_b32 s64, s63, 1
    s_add_u32 s60, s60, s64
    s_lshr_b32 s61, s2, 5
    s_lshl_b32 s61, s61, 1
    s_lshr_b32 s64, s63, 1
    s_add_u32 s61, s61, s64
    v_lshlrev_b32 v5, 4, v1
    s_mul_i32 s64, s61, 88064
    v_add_u32 v3, s64, v5
    s_mul_i32 s64, s60, 88064
    v_add_u32 v4, s64, v5
    v_mov_b32 v64, 0
    v_mov_b32 v65, 0
    v_mov_b32 v66, 0
    v_mov_b32 v67, 0
    v_mov_b32 v68, 0
    v_mov_b32 v69, 0
    v_mov_b32 v70, 0
    v_mov_b32 v71, 0
    v_mov_b32 v72, 0
    v_mov_b32 v73, 0
    v_mov_b32 v74, 0
    v_mov_b32 v75, 0
    v_mov_b32 v76, 0
    v_mov_b32 v77, 0
    v_mov_b32 v78, 0
    v_mov_b32 v79, 0
    buffer_load_dwordx4 v[8:11], v3, s[4:7], 0 offen offset:0
    buffer_load_dwordx4 v[12:15], v4, s[8:11], 0 offen offset:0
    buffer_load_dwordx4 v[16:19], v3, s[4:7], 0 offen offset:1024
    buffer_load_dwordx4 v[20:23], v4, s[8:11], 0 offen offset:1024
    buffer_load_dwordx4 v[24:27], v3, s[4:7], 0 offen offset:2048
    buffer_load_dwordx4 v[28:31], v4, s[8:11], 0 offen offset:2048
    buffer_load_dwordx4 v[32:35], v3, s[4:7], 0 offen offset:3072
    buffer_load_dwordx4 v[36:39], v4, s[8:11], 0 offen offset:3072
    v_add_u32 v3, 0x1000, v3
    v_add_u32 v4, 0x1000, v4
    buffer_load_dwordx4 v[40:43], v3, s[4:7], 0 offen offset:0
    buffer_load_dwordx4 v[44:47], v4, s[8:11], 0 offen offset:0
    buffer_load_dwordx4 v[48:51], v3, s[4:7], 0 offen offset:1024
    buffer_load_dwordx4 v[52:55], v4, s[8:11], 0 offen offset:1024
    s_waitcnt vmcnt(10)
    v_mfma_f32_32x32x16_bf16 v[64:79], v[8:11], v[12:15], v[64:79]
    buffer_load_dwordx4 v[8:11], v3, s[4:7], 0 offen offset:2048
    buffer_load_dwordx4 v[12:15], v4, s[8:11], 0 offen offset:2048
    s_waitcnt vmcnt(10)
    v_mfma_f32_32x32x16_bf16 v[64:79], v[16:19], v[20:23], v[64:79]
    buffer_load_dwordx4 v[16:19], v3, s[4:7], 0 offen offset:3072
    buffer_load_dwordx4 v[20:23], v4, s[8:11], 0 offen offset:3072
    v_add_u32 v3, 0x1000, v3
    v_add_u32 v4, 0x1000, v4
    s_waitcnt vmcnt(10)
    v_mfma_f32_32x32x16_bf16 v[64:79], v[24:27], v[28:31], v[64:79]
    buffer_load_dwordx4 v[24:27], v3, s[4:7], 0 offen offset:0
    buffer_load_dwordx4 v[28:31], v4, s[8:11], 0 offen offset:0
    s_waitcnt vmcnt(10)
    v_mfma_f32_32x32x16_bf16 v[64:79], v[32:35], v[36:39], v[64:79]
    buffer_load_dwordx4 v[32:35], v3, s[4:7], 0 offen offset:1024
    buffer_load_dwordx4 v[36:39], v4, s[8:11], 0 offen offset:1024
    s_waitcnt vmcnt(10)
    v_mfma_f32_32x32x16_bf16 v[64:79], v[40:43], v[44:47], v[64:79]
    buffer_load_dwordx4 v[40:43], v3, s[4:7], 0 offen offset:2048
    buffer_load_dwordx4 v[44:47], v4, s[8:11], 0 offen offset:2048
    s_waitcnt vmcnt(10)
    v_mfma_f32_32x32x16_bf16 v[64:79], v[48:51], v[52:55], v[64:79]
    buffer_load_dwordx4 v[48:51], v3, s[4:7], 0 offen offset:3072
    buffer_load_dwordx4 v[52:55], v4, s[8:11], 0 offen offset:3072
    v_add_u32 v3, 0x1000, v3
    v_add_u32 v4, 0x1000, v4
    s_waitcnt vmcnt(10)
    v_mfma_f32_32x32x16_bf16 v[64:79], v[8:11], v[12:15], v[64:79]
    buffer_load_dwordx4 v[8:11], v3, s[4:7], 0 offen offset:0
    buffer_load_dwordx4 v[12:15], v4, s[8:11], 0 offen offset:0
    s_waitcnt vmcnt(10)
    v_mfma_f32_32x32x16_bf16 v[64:79], v[16:19], v[20:23], v[64:79]
    buffer_load_dwordx4 v[16:19], v3, s[4:7], 0 offen offset:1024
    buffer_load_dwordx4 v[20:23], v4, s[8:11], 0 offen offset:1024
    s_waitcnt vmcnt(10)
    v_mfma_f32_32x32x16_bf16 v[64:79], v[24:27], v[28:31], v[64:79]
    buffer_load_dwordx4 v[24:27], v3, s[4:7], 0 offen offset:2048
    buffer_load_dwordx4 v[28:31], v4, s[8:11], 0 offen offset:2048
    s_waitcnt vmcnt(10)
    v_mfma_f32_32x32x16_bf16 v[64:79], v[32:35], v[36:39], v[64:79]
    buffer_load_dwordx4 v[32:35], v3, s[4:7], 0 offen offset:3072
    buffer_load_dwordx4 v[36:39], v4, s[8:11], 0 offen offset:3072
    v_add_u32 v3, 0x1000, v3
    v_add_u32 v4, 0x1000, v4
    s_waitcnt vmcnt(10)
    v_mfma_f32_32x32x16_bf16 v[64:79], v[40:43], v[44:47], v[64:79]
    buffer_load_dwordx4 v[40:43], v3, s[4:7], 0 offen offset:0
    buffer_load_dwordx4 v[44:47], v4, s[8:11], 0 offen offset:0
    s_waitcnt vmcnt(10)
    v_mfma_f32_32x32x16_bf16 v[64:79], v[48:51], v[52:55], v[64:79]
    buffer_load_dwordx4 v[48:51], v3, s[4:7], 0 offen offset:1024
    buffer_load_dwordx4 v[52:55], v4, s[8:11], 0 offen offset:1024
    s_waitcnt vmcnt(10)
    v_mfma_f32_32x32x16_bf16 v[64:79], v[8:11], v[12:15], v[64:79]
    buffer_load_dwordx4 v[8:11], v3, s[4:7], 0 offen offset:2048
    buffer_load_dwordx4 v[12:15], v4, s[8:11], 0 offen offset:2048
    s_waitcnt vmcnt(10)
    v_mfma_f32_32x32x16_bf16 v[64:79], v[16:19], v[20:23], v[64:79]
    buffer_load_dwordx4 v[16:19], v3, s[4:7], 0 offen offset:3072
    buffer_load_dwordx4 v[20:23], v4, s[8:11], 0 offen offset:3072
    v_add_u32 v3, 0x1000, v3
    v_add_u32 v4, 0x1000, v4
    s_waitcnt vmcnt(10)
    v_mfma_f32_32x32x16_bf16 v[64:79], v[24:27], v[28:31], v[64:79]
    buffer_load_dwordx4 v[24:27], v3, s[4:7], 0 offen offset:0
    buffer_load_dwordx4 v[28:31], v4, s[8:11], 0 offen offset:0
    s_waitcnt vmcnt(10)
    v_mfma_f32_32x32x16_bf16 v[64:79], v[32:35], v[36:39], v[64:79]
    buffer_load_dwordx4 v[32:35], v3, s[4:7], 0 offen offset:1024
    buffer_load_dwordx4 v[36:39], v4, s[8:11], 0 offen offset:1024
    s_waitcnt vmcnt(10)
    v_mfma_f32_32x32x16_bf16 v[64:79], v[40:43], v[44:47], v[64:79]
    buffer_load_dwordx4 v[40:43], v3, s[4:7], 0 offen offset:2048
    buffer_load_dwordx4 v[44:47], v4, s[8:11], 0 offen offset:2048
    s_waitcnt vmcnt(10)
    v_mfma_f32_32x32x16_bf16 v[64:79], v[48:51], v[52:55], v[64:79]
    buffer_load_dwordx4 v[48:51], v3, s[4:7], 0 offen offset:3072
    buffer_load_dwordx4 v[52:55], v4, s[8:11], 0 offen offset:3072
    v_add_u32 v3, 0x1000, v3
    v_add_u32 v4, 0x1000, v4
    s_waitcnt vmcnt(10)
    v_mfma_f32_32x32x16_bf16 v[64:79], v[8:11], v[12:15], v[64:79]
    buffer_load_dwordx4 v[8:11], v3, s[4:7], 0 offen offset:0
    buffer_load_dwordx4 v[12:15], v4, s[8:11], 0 offen offset:0
    s_waitcnt vmcnt(10)
    v_mfma_f32_32x32x16_bf16 v[64:79], v[16:19], v[20:23], v[64:79]
    buffer_load_dwordx4 v[16:19], v3, s[4:7], 0 offen offset:1024
    buffer_load_dwordx4 v[20:23], v4, s[8:11], 0 offen offset:1024
    s_waitcnt vmcnt(10)
    v_mfma_f32_32x32x16_bf16 v[64:79], v[24:27], v[28:31], v[64:79]
    buffer_load_dwordx4 v[24:27], v3, s[4:7], 0 offen offset:2048
    buffer_load_dwordx4 v[28:31], v4, s[8:11], 0 offen offset:2048
    s_waitcnt vmcnt(10)
    v_mfma_f32_32x32x16_bf16 v[64:79], v[32:35], v[36:39], v[64:79]
    buffer_load_dwordx4 v[32:35], v3, s[4:7], 0 offen offset:3072
    buffer_load_dwordx4 v[36:39], v4, s[8:11], 0 offen offset:3072
    v_add_u32 v3, 0x1000, v3
    v_add_u32 v4, 0x1000, v4
    s_waitcnt vmcnt(10)
    v_mfma_f32_32x32x16_bf16 v[64:79], v[40:43], v[44:47], v[64:79]
    buffer_load_dwordx4 v[40:43], v3, s[4:7], 0 offen offset:0
    buffer_load_dwordx4 v[44:47], v4, s[8:11], 0 offen offset:0
    s_waitcnt vmcnt(10)
    v_mfma_f32_32x32x16_bf16 v[64:79], v[48:51], v[52:55], v[64:79]
    buffer_load_dwordx4 v[48:51], v3, s[4:7], 0 offen offset:1024
    buffer_load_dwordx4 v[52:55], v4, s[8:11], 0 offen offset:1024
    s_waitcnt vmcnt(10)
    v_mfma_f32_32x32x16_bf16 v[64:79], v[8:11], v[12:15], v[64:79]
    buffer_load_dwordx4 v[8:11], v3, s[4:7], 0 offen offset:2048
    buffer_load_dwordx4 v[12:15], v4, s[8:11], 0 offen offset:2048
    s_waitcnt vmcnt(10)
    v_mfma_f32_32x32x16_bf16 v[64:79], v[16:19], v[20:23], v[64:79]
    buffer_load_dwordx4 v[16:19], v3, s[4:7], 0 offen offset:3072
    buffer_load_dwordx4 v[20:23], v4, s[8:11], 0 offen offset:3072
    v_add_u32 v3, 0x1000, v3
    v_add_u32 v4, 0x1000, v4
    s_waitcnt vmcnt(10)
    v_mfma_f32_32x32x16_bf16 v[64:79], v[24:27], v[28:31], v[64:79]
    buffer_load_dwordx4 v[24:27], v3, s[4:7], 0 offen offset:0
    buffer_load_dwordx4 v[28:31], v4, s[8:11], 0 offen offset:0
    s_waitcnt vmcnt(10)
    v_mfma_f32_32x32x16_bf16 v[64:79], v[32:35], v[36:39], v[64:79]
    buffer_load_dwordx4 v[32:35], v3, s[4:7], 0 offen offset:1024
    buffer_load_dwordx4 v[36:39], v4, s[8:11], 0 offen offset:1024
    s_waitcnt vmcnt(10)
    v_mfma_f32_32x32x16_bf16 v[64:79], v[40:43], v[44:47], v[64:79]
    buffer_load_dwordx4 v[40:43], v3, s[4:7], 0 offen offset:2048
    buffer_load_dwordx4 v[44:47], v4, s[8:11], 0 offen offset:2048
    s_waitcnt vmcnt(10)
    v_mfma_f32_32x32x16_bf16 v[64:79], v[48:51], v[52:55], v[64:79]
    buffer_load_dwordx4 v[48:51], v3, s[4:7], 0 offen offset:3072
    buffer_load_dwordx4 v[52:55], v4, s[8:11], 0 offen offset:3072
    v_add_u32 v3, 0x1000, v3
    v_add_u32 v4, 0x1000, v4
    s_waitcnt vmcnt(10)
    v_mfma_f32_32x32x16_bf16 v[64:79], v[8:11], v[12:15], v[64:79]
    buffer_load_dwordx4 v[8:11], v3, s[4:7], 0 offen offset:0
    buffer_load_dwordx4 v[12:15], v4, s[8:11], 0 offen offset:0
    s_waitcnt vmcnt(10)
    v_mfma_f32_32x32x16_bf16 v[64:79], v[16:19], v[20:23], v[64:79]
    buffer_load_dwordx4 v[16:19], v3, s[4:7], 0 offen offset:1024
    buffer_load_dwordx4 v[20:23], v4, s[8:11], 0 offen offset:1024
    s_waitcnt vmcnt(10)
    v_mfma_f32_32x32x16_bf16 v[64:79], v[24:27], v[28:31], v[64:79]
    buffer_load_dwordx4 v[24:27], v3, s[4:7], 0 offen offset:2048
    buffer_load_dwordx4 v[28:31], v4, s[8:11], 0 offen offset:2048
    s_waitcnt vmcnt(10)
    v_mfma_f32_32x32x16_bf16 v[64:79], v[32:35], v[36:39], v[64:79]
    buffer_load_dwordx4 v[32:35], v3, s[4:7], 0 offen offset:3072
    buffer_load_dwordx4 v[36:39], v4, s[8:11], 0 offen offset:3072
    v_add_u32 v3, 0x1000, v3
    v_add_u32 v4, 0x1000, v4
    s_waitcnt vmcnt(10)
    v_mfma_f32_32x32x16_bf16 v[64:79], v[40:43], v[44:47], v[64:79]
    buffer_load_dwordx4 v[40:43], v3, s[4:7], 0 offen offset:0
    buffer_load_dwordx4 v[44:47], v4, s[8:11], 0 offen offset:0
    s_waitcnt vmcnt(10)
    v_mfma_f32_32x32x16_bf16 v[64:79], v[48:51], v[52:55], v[64:79]
    buffer_load_dwordx4 v[48:51], v3, s[4:7], 0 offen offset:1024
    buffer_load_dwordx4 v[52:55], v4, s[8:11], 0 offen offset:1024
    s_waitcnt vmcnt(10)
    v_mfma_f32_32x32x16_bf16 v[64:79], v[8:11], v[12:15], v[64:79]
    buffer_load_dwordx4 v[8:11], v3, s[4:7], 0 offen offset:2048
    buffer_load_dwordx4 v[12:15], v4, s[8:11], 0 offen offset:2048
    s_waitcnt vmcnt(10)
    v_mfma_f32_32x32x16_bf16 v[64:79], v[16:19], v[20:23], v[64:79]
    buffer_load_dwordx4 v[16:19], v3, s[4:7], 0 offen offset:3072
    buffer_load_dwordx4 v[20:23], v4, s[8:11], 0 offen offset:3072
    v_add_u32 v3, 0x1000, v3
    v_add_u32 v4, 0x1000, v4
    s_waitcnt vmcnt(10)
    v_mfma_f32_32x32x16_bf16 v[64:79], v[24:27], v[28:31], v[64:79]
    buffer_load_dwordx4 v[24:27], v3, s[4:7], 0 offen offset:0
    buffer_load_dwordx4 v[28:31], v4, s[8:11], 0 offen offset:0
    s_waitcnt vmcnt(10)
    v_mfma_f32_32x32x16_bf16 v[64:79], v[32:35], v[36:39], v[64:79]
    buffer_load_dwordx4 v[32:35], v3, s[4:7], 0 offen offset:1024
    buffer_load_dwordx4 v[36:39], v4, s[8:11], 0 offen offset:1024
    s_waitcnt vmcnt(10)
    v_mfma_f32_32x32x16_bf16 v[64:79], v[40:43], v[44:47], v[64:79]
    buffer_load_dwordx4 v[40:43], v3, s[4:7], 0 offen offset:2048
    buffer_load_dwordx4 v[44:47], v4, s[8:11], 0 offen offset:2048
    s_waitcnt vmcnt(10)
    v_mfma_f32_32x32x16_bf16 v[64:79], v[48:51], v[52:55], v[64:79]
    buffer_load_dwordx4 v[48:51], v3, s[4:7], 0 offen offset:3072
    buffer_load_dwordx4 v[52:55], v4, s[8:11], 0 offen offset:3072
    v_add_u32 v3, 0x1000, v3
    v_add_u32 v4, 0x1000, v4
    s_waitcnt vmcnt(10)
    v_mfma_f32_32x32x16_bf16 v[64:79], v[8:11], v[12:15], v[64:79]
    buffer_load_dwordx4 v[8:11], v3, s[4:7], 0 offen offset:0
    buffer_load_dwordx4 v[12:15], v4, s[8:11], 0 offen offset:0
    s_waitcnt vmcnt(10)
    v_mfma_f32_32x32x16_bf16 v[64:79], v[16:19], v[20:23], v[64:79]
    buffer_load_dwordx4 v[16:19], v3, s[4:7], 0 offen offset:1024
    buffer_load_dwordx4 v[20:23], v4, s[8:11], 0 offen offset:1024
    s_waitcnt vmcnt(10)
    v_mfma_f32_32x32x16_bf16 v[64:79], v[24:27], v[28:31], v[64:79]
    buffer_load_dwordx4 v[24:27], v3, s[4:7], 0 offen offset:2048
    buffer_load_dwordx4 v[28:31], v4, s[8:11], 0 offen offset:2048
    s_waitcnt vmcnt(10)
    v_mfma_f32_32x32x16_bf16 v[64:79], v[32:35], v[36:39], v[64:79]
    buffer_load_dwordx4 v[32:35], v3, s[4:7], 0 offen offset:3072
    buffer_load_dwordx4 v[36:39], v4, s[8:11], 0 offen offset:3072
    v_add_u32 v3, 0x1000, v3
    v_add_u32 v4, 0x1000, v4
    s_waitcnt vmcnt(10)
    v_mfma_f32_32x32x16_bf16 v[64:79], v[40:43], v[44:47], v[64:79]
    buffer_load_dwordx4 v[40:43], v3, s[4:7], 0 offen offset:0
    buffer_load_dwordx4 v[44:47], v4, s[8:11], 0 offen offset:0
    s_waitcnt vmcnt(10)
    v_mfma_f32_32x32x16_bf16 v[64:79], v[48:51], v[52:55], v[64:79]
    buffer_load_dwordx4 v[48:51], v3, s[4:7], 0 offen offset:1024
    buffer_load_dwordx4 v[52:55], v4, s[8:11], 0 offen offset:1024
    s_waitcnt vmcnt(10)
    v_mfma_f32_32x32x16_bf16 v[64:79], v[8:11], v[12:15], v[64:79]
    buffer_load_dwordx4 v[8:11], v3, s[4:7], 0 offen offset:2048
    buffer_load_dwordx4 v[12:15], v4, s[8:11], 0 offen offset:2048
    s_waitcnt vmcnt(10)
    v_mfma_f32_32x32x16_bf16 v[64:79], v[16:19], v[20:23], v[64:79]
    buffer_load_dwordx4 v[16:19], v3, s[4:7], 0 offen offset:3072
    buffer_load_dwordx4 v[20:23], v4, s[8:11], 0 offen offset:3072
    v_add_u32 v3, 0x1000, v3
    v_add_u32 v4, 0x1000, v4
    s_waitcnt vmcnt(10)
    v_mfma_f32_32x32x16_bf16 v[64:79], v[24:27], v[28:31], v[64:79]
    buffer_load_dwordx4 v[24:27], v3, s[4:7], 0 offen offset:0
    buffer_load_dwordx4 v[28:31], v4, s[8:11], 0 offen offset:0
    s_waitcnt vmcnt(10)
    v_mfma_f32_32x32x16_bf16 v[64:79], v[32:35], v[36:39], v[64:79]
    buffer_load_dwordx4 v[32:35], v3, s[4:7], 0 offen offset:1024
    buffer_load_dwordx4 v[36:39], v4, s[8:11], 0 offen offset:1024
    s_waitcnt vmcnt(10)
    v_mfma_f32_32x32x16_bf16 v[64:79], v[40:43], v[44:47], v[64:79]
    buffer_load_dwordx4 v[40:43], v3, s[4:7], 0 offen offset:2048
    buffer_load_dwordx4 v[44:47], v4, s[8:11], 0 offen offset:2048
    s_waitcnt vmcnt(10)
    v_mfma_f32_32x32x16_bf16 v[64:79], v[48:51], v[52:55], v[64:79]
    buffer_load_dwordx4 v[48:51], v3, s[4:7], 0 offen offset:3072
    buffer_load_dwordx4 v[52:55], v4, s[8:11], 0 offen offset:3072
    v_add_u32 v3, 0x1000, v3
    v_add_u32 v4, 0x1000, v4
    s_waitcnt vmcnt(10)
    v_mfma_f32_32x32x16_bf16 v[64:79], v[8:11], v[12:15], v[64:79]
    buffer_load_dwordx4 v[8:11], v3, s[4:7], 0 offen offset:0
    buffer_load_dwordx4 v[12:15], v4, s[8:11], 0 offen offset:0
    s_waitcnt vmcnt(10)
    v_mfma_f32_32x32x16_bf16 v[64:79], v[16:19], v[20:23], v[64:79]
    buffer_load_dwordx4 v[16:19], v3, s[4:7], 0 offen offset:1024
    buffer_load_dwordx4 v[20:23], v4, s[8:11], 0 offen offset:1024
    s_waitcnt vmcnt(10)
    v_mfma_f32_32x32x16_bf16 v[64:79], v[24:27], v[28:31], v[64:79]
    buffer_load_dwordx4 v[24:27], v3, s[4:7], 0 offen offset:2048
    buffer_load_dwordx4 v[28:31], v4, s[8:11], 0 offen offset:2048
    s_waitcnt vmcnt(10)
    v_mfma_f32_32x32x16_bf16 v[64:79], v[32:35], v[36:39], v[64:79]
    buffer_load_dwordx4 v[32:35], v3, s[4:7], 0 offen offset:3072
    buffer_load_dwordx4 v[36:39], v4, s[8:11], 0 offen offset:3072
    v_add_u32 v3, 0x1000, v3
    v_add_u32 v4, 0x1000, v4
    s_waitcnt vmcnt(10)
    v_mfma_f32_32x32x16_bf16 v[64:79], v[40:43], v[44:47], v[64:79]
    buffer_load_dwordx4 v[40:43], v3, s[4:7], 0 offen offset:0
    buffer_load_dwordx4 v[44:47], v4, s[8:11], 0 offen offset:0
    s_waitcnt vmcnt(10)
    v_mfma_f32_32x32x16_bf16 v[64:79], v[48:51], v[52:55], v[64:79]
    buffer_load_dwordx4 v[48:51], v3, s[4:7], 0 offen offset:1024
    buffer_load_dwordx4 v[52:55], v4, s[8:11], 0 offen offset:1024
    s_waitcnt vmcnt(10)
    v_mfma_f32_32x32x16_bf16 v[64:79], v[8:11], v[12:15], v[64:79]
    buffer_load_dwordx4 v[8:11], v3, s[4:7], 0 offen offset:2048
    buffer_load_dwordx4 v[12:15], v4, s[8:11], 0 offen offset:2048
    s_waitcnt vmcnt(10)
    v_mfma_f32_32x32x16_bf16 v[64:79], v[16:19], v[20:23], v[64:79]
    buffer_load_dwordx4 v[16:19], v3, s[4:7], 0 offen offset:3072
    buffer_load_dwordx4 v[20:23], v4, s[8:11], 0 offen offset:3072
    v_add_u32 v3, 0x1000, v3
    v_add_u32 v4, 0x1000, v4
    s_waitcnt vmcnt(10)
    v_mfma_f32_32x32x16_bf16 v[64:79], v[24:27], v[28:31], v[64:79]
    buffer_load_dwordx4 v[24:27], v3, s[4:7], 0 offen offset:0
    buffer_load_dwordx4 v[28:31], v4, s[8:11], 0 offen offset:0
    s_waitcnt vmcnt(10)
    v_mfma_f32_32x32x16_bf16 v[64:79], v[32:35], v[36:39], v[64:79]
    buffer_load_dwordx4 v[32:35], v3, s[4:7], 0 offen offset:1024
    buffer_load_dwordx4 v[36:39], v4, s[8:11], 0 offen offset:1024
    s_waitcnt vmcnt(10)
    v_mfma_f32_32x32x16_bf16 v[64:79], v[40:43], v[44:47], v[64:79]
    buffer_load_dwordx4 v[40:43], v3, s[4:7], 0 offen offset:2048
    buffer_load_dwordx4 v[44:47], v4, s[8:11], 0 offen offset:2048
    s_waitcnt vmcnt(10)
    v_mfma_f32_32x32x16_bf16 v[64:79], v[48:51], v[52:55], v[64:79]
    buffer_load_dwordx4 v[48:51], v3, s[4:7], 0 offen offset:3072
    buffer_load_dwordx4 v[52:55], v4, s[8:11], 0 offen offset:3072
    v_add_u32 v3, 0x1000, v3
    v_add_u32 v4, 0x1000, v4
    s_waitcnt vmcnt(10)
    v_mfma_f32_32x32x16_bf16 v[64:79], v[8:11], v[12:15], v[64:79]
    buffer_load_dwordx4 v[8:11], v3, s[4:7], 0 offen offset:0
    buffer_load_dwordx4 v[12:15], v4, s[8:11], 0 offen offset:0
    s_waitcnt vmcnt(10)
    v_mfma_f32_32x32x16_bf16 v[64:79], v[16:19], v[20:23], v[64:79]
    buffer_load_dwordx4 v[16:19], v3, s[4:7], 0 offen offset:1024
    buffer_load_dwordx4 v[20:23], v4, s[8:11], 0 offen offset:1024
    s_waitcnt vmcnt(10)
    v_mfma_f32_32x32x16_bf16 v[64:79], v[24:27], v[28:31], v[64:79]
    buffer_load_dwordx4 v[24:27], v3, s[4:7], 0 offen offset:2048
    buffer_load_dwordx4 v[28:31], v4, s[8:11], 0 offen offset:2048
    s_waitcnt vmcnt(10)
    v_mfma_f32_32x32x16_bf16 v[64:79], v[32:35], v[36:39], v[64:79]
    buffer_load_dwordx4 v[32:35], v3, s[4:7], 0 offen offset:3072
    buffer_load_dwordx4 v[36:39], v4, s[8:11], 0 offen offset:3072
    v_add_u32 v3, 0x1000, v3
    v_add_u32 v4, 0x1000, v4
    s_waitcnt vmcnt(10)
    v_mfma_f32_32x32x16_bf16 v[64:79], v[40:43], v[44:47], v[64:79]
    buffer_load_dwordx4 v[40:43], v3, s[4:7], 0 offen offset:0
    buffer_load_dwordx4 v[44:47], v4, s[8:11], 0 offen offset:0
    s_waitcnt vmcnt(10)
    v_mfma_f32_32x32x16_bf16 v[64:79], v[48:51], v[52:55], v[64:79]
    buffer_load_dwordx4 v[48:51], v3, s[4:7], 0 offen offset:1024
    buffer_load_dwordx4 v[52:55], v4, s[8:11], 0 offen offset:1024
    s_waitcnt vmcnt(10)
    v_mfma_f32_32x32x16_bf16 v[64:79], v[8:11], v[12:15], v[64:79]
    buffer_load_dwordx4 v[8:11], v3, s[4:7], 0 offen offset:2048
    buffer_load_dwordx4 v[12:15], v4, s[8:11], 0 offen offset:2048
    s_waitcnt vmcnt(10)
    v_mfma_f32_32x32x16_bf16 v[64:79], v[16:19], v[20:23], v[64:79]
    buffer_load_dwordx4 v[16:19], v3, s[4:7], 0 offen offset:3072
    buffer_load_dwordx4 v[20:23], v4, s[8:11], 0 offen offset:3072
    v_add_u32 v3, 0x1000, v3
    v_add_u32 v4, 0x1000, v4
    s_waitcnt vmcnt(10)
    v_mfma_f32_32x32x16_bf16 v[64:79], v[24:27], v[28:31], v[64:79]
    buffer_load_dwordx4 v[24:27], v3, s[4:7], 0 offen offset:0
    buffer_load_dwordx4 v[28:31], v4, s[8:11], 0 offen offset:0
    s_waitcnt vmcnt(10)
    v_mfma_f32_32x32x16_bf16 v[64:79], v[32:35], v[36:39], v[64:79]
    buffer_load_dwordx4 v[32:35], v3, s[4:7], 0 offen offset:1024
    buffer_load_dwordx4 v[36:39], v4, s[8:11], 0 offen offset:1024
    s_waitcnt vmcnt(10)
    v_mfma_f32_32x32x16_bf16 v[64:79], v[40:43], v[44:47], v[64:79]
    buffer_load_dwordx4 v[40:43], v3, s[4:7], 0 offen offset:2048
    buffer_load_dwordx4 v[44:47], v4, s[8:11], 0 offen offset:2048
    s_waitcnt vmcnt(10)
    v_mfma_f32_32x32x16_bf16 v[64:79], v[48:51], v[52:55], v[64:79]
    buffer_load_dwordx4 v[48:51], v3, s[4:7], 0 offen offset:3072
    buffer_load_dwordx4 v[52:55], v4, s[8:11], 0 offen offset:3072
    v_add_u32 v3, 0x1000, v3
    v_add_u32 v4, 0x1000, v4
    s_waitcnt vmcnt(10)
    v_mfma_f32_32x32x16_bf16 v[64:79], v[8:11], v[12:15], v[64:79]
    buffer_load_dwordx4 v[8:11], v3, s[4:7], 0 offen offset:0
    buffer_load_dwordx4 v[12:15], v4, s[8:11], 0 offen offset:0
    s_waitcnt vmcnt(10)
    v_mfma_f32_32x32x16_bf16 v[64:79], v[16:19], v[20:23], v[64:79]
    buffer_load_dwordx4 v[16:19], v3, s[4:7], 0 offen offset:1024
    buffer_load_dwordx4 v[20:23], v4, s[8:11], 0 offen offset:1024
    s_waitcnt vmcnt(10)
    v_mfma_f32_32x32x16_bf16 v[64:79], v[24:27], v[28:31], v[64:79]
    s_waitcnt vmcnt(8)
    v_mfma_f32_32x32x16_bf16 v[64:79], v[32:35], v[36:39], v[64:79]
    s_waitcnt vmcnt(6)
    v_mfma_f32_32x32x16_bf16 v[64:79], v[40:43], v[44:47], v[64:79]
    s_waitcnt vmcnt(4)
    v_mfma_f32_32x32x16_bf16 v[64:79], v[48:51], v[52:55], v[64:79]
    s_waitcnt vmcnt(2)
    v_mfma_f32_32x32x16_bf16 v[64:79], v[8:11], v[12:15], v[64:79]
    s_waitcnt vmcnt(0)
    v_mfma_f32_32x32x16_bf16 v[64:79], v[16:19], v[20:23], v[64:79]
    v_and_b32 v6, 31, v1
    s_lshl_b32 s64, s60, 5
    v_add_u32 v6, s64, v6
    v_lshlrev_b32 v6, 10, v6
    v_lshrrev_b32 v7, 5, v1
    v_lshl_add_u32 v6, v7, 3, v6
    s_lshl_b32 s64, s61, 6
    v_add_u32 v6, s64, v6
    buffer_load_dwordx2 v[8:9], v6, s[12:15], 0 offen offset:0
    buffer_load_dwordx2 v[10:11], v6, s[12:15], 0 offen offset:16
    buffer_load_dwordx2 v[12:13], v6, s[12:15], 0 offen offset:32
    buffer_load_dwordx2 v[14:15], v6, s[12:15], 0 offen offset:48
    s_nop 15
    s_waitcnt vmcnt(0)
    v_cvt_pk_bf16_f32 v20, v64, v65
    v_lshlrev_b32 v21, 16, v20
    v_and_b32 v22, 0xffff0000, v20
    v_lshlrev_b32 v23, 16, v8
    v_and_b32 v24, 0xffff0000, v8
    v_add_f32 v21, v21, v23
    v_add_f32 v22, v22, v24
    v_cvt_pk_bf16_f32 v26, v21, v22
    v_cvt_pk_bf16_f32 v20, v66, v67
    v_lshlrev_b32 v21, 16, v20
    v_and_b32 v22, 0xffff0000, v20
    v_lshlrev_b32 v23, 16, v9
    v_and_b32 v24, 0xffff0000, v9
    v_add_f32 v21, v21, v23
    v_add_f32 v22, v22, v24
    v_cvt_pk_bf16_f32 v27, v21, v22
    buffer_store_dwordx2 v[26:27], v6, s[16:19], 0 offen offset:0
    s_nop 1
    v_cvt_pk_bf16_f32 v20, v68, v69
    v_lshlrev_b32 v21, 16, v20
    v_and_b32 v22, 0xffff0000, v20
    v_lshlrev_b32 v23, 16, v10
    v_and_b32 v24, 0xffff0000, v10
    v_add_f32 v21, v21, v23
    v_add_f32 v22, v22, v24
    v_cvt_pk_bf16_f32 v26, v21, v22
    v_cvt_pk_bf16_f32 v20, v70, v71
    v_lshlrev_b32 v21, 16, v20
    v_and_b32 v22, 0xffff0000, v20
    v_lshlrev_b32 v23, 16, v11
    v_and_b32 v24, 0xffff0000, v11
    v_add_f32 v21, v21, v23
    v_add_f32 v22, v22, v24
    v_cvt_pk_bf16_f32 v27, v21, v22
    buffer_store_dwordx2 v[26:27], v6, s[16:19], 0 offen offset:16
    s_nop 1
    v_cvt_pk_bf16_f32 v20, v72, v73
    v_lshlrev_b32 v21, 16, v20
    v_and_b32 v22, 0xffff0000, v20
    v_lshlrev_b32 v23, 16, v12
    v_and_b32 v24, 0xffff0000, v12
    v_add_f32 v21, v21, v23
    v_add_f32 v22, v22, v24
    v_cvt_pk_bf16_f32 v26, v21, v22
    v_cvt_pk_bf16_f32 v20, v74, v75
    v_lshlrev_b32 v21, 16, v20
    v_and_b32 v22, 0xffff0000, v20
    v_lshlrev_b32 v23, 16, v13
    v_and_b32 v24, 0xffff0000, v13
    v_add_f32 v21, v21, v23
    v_add_f32 v22, v22, v24
    v_cvt_pk_bf16_f32 v27, v21, v22
    buffer_store_dwordx2 v[26:27], v6, s[16:19], 0 offen offset:32
    s_nop 1
    v_cvt_pk_bf16_f32 v20, v76, v77
    v_lshlrev_b32 v21, 16, v20
    v_and_b32 v22, 0xffff0000, v20
    v_lshlrev_b32 v23, 16, v14
    v_and_b32 v24, 0xffff0000, v14
    v_add_f32 v21, v21, v23
    v_add_f32 v22, v22, v24
    v_cvt_pk_bf16_f32 v26, v21, v22
    v_cvt_pk_bf16_f32 v20, v78, v79
    v_lshlrev_b32 v21, 16, v20
    v_and_b32 v22, 0xffff0000, v20
    v_lshlrev_b32 v23, 16, v15
    v_and_b32 v24, 0xffff0000, v15
    v_add_f32 v21, v21, v23
    v_add_f32 v22, v22, v24
    v_cvt_pk_bf16_f32 v27, v21, v22
    buffer_store_dwordx2 v[26:27], v6, s[16:19], 0 offen offset:48
    s_nop 1
L_g2a_kernel_end:
    s_endpgm
.globl g2b_kernel
.p2align 8
.type g2b_kernel,@function
g2b_kernel:
    s_load_dwordx2 s[40:41], s[0:1], 80
    s_load_dwordx2 s[58:59], s[0:1], 96
    s_cmp_ge_u32 s2, 256
    s_cbranch_scc1 L_g2b_kernel_end
    v_and_b32 v1, 63, v0
    v_lshrrev_b32 v2, 6, v0
    s_waitcnt lgkmcnt(0)
    s_add_u32 s4, s58, 6291456
    s_addc_u32 s5, s59, 0
    s_mov_b32 s6, 1409024
    s_mov_b32 s7, 0x00020000
    s_add_u32 s8, s58, 8388608
    s_addc_u32 s9, s59, 0
    s_mov_b32 s10, 5636096
    s_mov_b32 s11, 0x00020000
    s_add_u32 s12, s58, 20971520
    s_addc_u32 s13, s59, 0
    s_mov_b32 s14, 2097152
    s_mov_b32 s15, 0x00020000
    s_mov_b32 s16, s40
    s_mov_b32 s17, s41
    s_mov_b32 s18, 2097152
    s_mov_b32 s19, 0x00020000
    v_readfirstlane_b32 s63, v2
    s_and_b32 s60, s2, 31
    s_lshl_b32 s60, s60, 1
    s_and_b32 s64, s63, 1
    s_add_u32 s60, s60, s64
    s_lshr_b32 s61, s2, 5
    s_lshl_b32 s61, s61, 1
    s_lshr_b32 s64, s63, 1
    s_add_u32 s61, s61, s64
    v_lshlrev_b32 v5, 4, v1
    s_mul_i32 s64, s61, 88064
    v_add_u32 v3, s64, v5
    s_mul_i32 s64, s60, 88064
    v_add_u32 v4, s64, v5
    v_mov_b32 v64, 0
    v_mov_b32 v65, 0
    v_mov_b32 v66, 0
    v_mov_b32 v67, 0
    v_mov_b32 v68, 0
    v_mov_b32 v69, 0
    v_mov_b32 v70, 0
    v_mov_b32 v71, 0
    v_mov_b32 v72, 0
    v_mov_b32 v73, 0
    v_mov_b32 v74, 0
    v_mov_b32 v75, 0
    v_mov_b32 v76, 0
    v_mov_b32 v77, 0
    v_mov_b32 v78, 0
    v_mov_b32 v79, 0
    buffer_load_dwordx4 v[8:11], v3, s[4:7], 0 offen offset:0
    buffer_load_dwordx4 v[12:15], v4, s[8:11], 0 offen offset:0
    buffer_load_dwordx4 v[16:19], v3, s[4:7], 0 offen offset:1024
    buffer_load_dwordx4 v[20:23], v4, s[8:11], 0 offen offset:1024
    buffer_load_dwordx4 v[24:27], v3, s[4:7], 0 offen offset:2048
    buffer_load_dwordx4 v[28:31], v4, s[8:11], 0 offen offset:2048
    buffer_load_dwordx4 v[32:35], v3, s[4:7], 0 offen offset:3072
    buffer_load_dwordx4 v[36:39], v4, s[8:11], 0 offen offset:3072
    v_add_u32 v3, 0x1000, v3
    v_add_u32 v4, 0x1000, v4
    buffer_load_dwordx4 v[40:43], v3, s[4:7], 0 offen offset:0
    buffer_load_dwordx4 v[44:47], v4, s[8:11], 0 offen offset:0
    buffer_load_dwordx4 v[48:51], v3, s[4:7], 0 offen offset:1024
    buffer_load_dwordx4 v[52:55], v4, s[8:11], 0 offen offset:1024
    s_waitcnt vmcnt(10)
    v_mfma_f32_32x32x16_bf16 v[64:79], v[8:11], v[12:15], v[64:79]
    buffer_load_dwordx4 v[8:11], v3, s[4:7], 0 offen offset:2048
    buffer_load_dwordx4 v[12:15], v4, s[8:11], 0 offen offset:2048
    s_waitcnt vmcnt(10)
    v_mfma_f32_32x32x16_bf16 v[64:79], v[16:19], v[20:23], v[64:79]
    buffer_load_dwordx4 v[16:19], v3, s[4:7], 0 offen offset:3072
    buffer_load_dwordx4 v[20:23], v4, s[8:11], 0 offen offset:3072
    v_add_u32 v3, 0x1000, v3
    v_add_u32 v4, 0x1000, v4
    s_waitcnt vmcnt(10)
    v_mfma_f32_32x32x16_bf16 v[64:79], v[24:27], v[28:31], v[64:79]
    buffer_load_dwordx4 v[24:27], v3, s[4:7], 0 offen offset:0
    buffer_load_dwordx4 v[28:31], v4, s[8:11], 0 offen offset:0
    s_waitcnt vmcnt(10)
    v_mfma_f32_32x32x16_bf16 v[64:79], v[32:35], v[36:39], v[64:79]
    buffer_load_dwordx4 v[32:35], v3, s[4:7], 0 offen offset:1024
    buffer_load_dwordx4 v[36:39], v4, s[8:11], 0 offen offset:1024
    s_waitcnt vmcnt(10)
    v_mfma_f32_32x32x16_bf16 v[64:79], v[40:43], v[44:47], v[64:79]
    buffer_load_dwordx4 v[40:43], v3, s[4:7], 0 offen offset:2048
    buffer_load_dwordx4 v[44:47], v4, s[8:11], 0 offen offset:2048
    s_waitcnt vmcnt(10)
    v_mfma_f32_32x32x16_bf16 v[64:79], v[48:51], v[52:55], v[64:79]
    buffer_load_dwordx4 v[48:51], v3, s[4:7], 0 offen offset:3072
    buffer_load_dwordx4 v[52:55], v4, s[8:11], 0 offen offset:3072
    v_add_u32 v3, 0x1000, v3
    v_add_u32 v4, 0x1000, v4
    s_waitcnt vmcnt(10)
    v_mfma_f32_32x32x16_bf16 v[64:79], v[8:11], v[12:15], v[64:79]
    buffer_load_dwordx4 v[8:11], v3, s[4:7], 0 offen offset:0
    buffer_load_dwordx4 v[12:15], v4, s[8:11], 0 offen offset:0
    s_waitcnt vmcnt(10)
    v_mfma_f32_32x32x16_bf16 v[64:79], v[16:19], v[20:23], v[64:79]
    buffer_load_dwordx4 v[16:19], v3, s[4:7], 0 offen offset:1024
    buffer_load_dwordx4 v[20:23], v4, s[8:11], 0 offen offset:1024
    s_waitcnt vmcnt(10)
    v_mfma_f32_32x32x16_bf16 v[64:79], v[24:27], v[28:31], v[64:79]
    buffer_load_dwordx4 v[24:27], v3, s[4:7], 0 offen offset:2048
    buffer_load_dwordx4 v[28:31], v4, s[8:11], 0 offen offset:2048
    s_waitcnt vmcnt(10)
    v_mfma_f32_32x32x16_bf16 v[64:79], v[32:35], v[36:39], v[64:79]
    buffer_load_dwordx4 v[32:35], v3, s[4:7], 0 offen offset:3072
    buffer_load_dwordx4 v[36:39], v4, s[8:11], 0 offen offset:3072
    v_add_u32 v3, 0x1000, v3
    v_add_u32 v4, 0x1000, v4
    s_waitcnt vmcnt(10)
    v_mfma_f32_32x32x16_bf16 v[64:79], v[40:43], v[44:47], v[64:79]
    buffer_load_dwordx4 v[40:43], v3, s[4:7], 0 offen offset:0
    buffer_load_dwordx4 v[44:47], v4, s[8:11], 0 offen offset:0
    s_waitcnt vmcnt(10)
    v_mfma_f32_32x32x16_bf16 v[64:79], v[48:51], v[52:55], v[64:79]
    buffer_load_dwordx4 v[48:51], v3, s[4:7], 0 offen offset:1024
    buffer_load_dwordx4 v[52:55], v4, s[8:11], 0 offen offset:1024
    s_waitcnt vmcnt(10)
    v_mfma_f32_32x32x16_bf16 v[64:79], v[8:11], v[12:15], v[64:79]
    buffer_load_dwordx4 v[8:11], v3, s[4:7], 0 offen offset:2048
    buffer_load_dwordx4 v[12:15], v4, s[8:11], 0 offen offset:2048
    s_waitcnt vmcnt(10)
    v_mfma_f32_32x32x16_bf16 v[64:79], v[16:19], v[20:23], v[64:79]
    buffer_load_dwordx4 v[16:19], v3, s[4:7], 0 offen offset:3072
    buffer_load_dwordx4 v[20:23], v4, s[8:11], 0 offen offset:3072
    v_add_u32 v3, 0x1000, v3
    v_add_u32 v4, 0x1000, v4
    s_waitcnt vmcnt(10)
    v_mfma_f32_32x32x16_bf16 v[64:79], v[24:27], v[28:31], v[64:79]
    buffer_load_dwordx4 v[24:27], v3, s[4:7], 0 offen offset:0
    buffer_load_dwordx4 v[28:31], v4, s[8:11], 0 offen offset:0
    s_waitcnt vmcnt(10)
    v_mfma_f32_32x32x16_bf16 v[64:79], v[32:35], v[36:39], v[64:79]
    buffer_load_dwordx4 v[32:35], v3, s[4:7], 0 offen offset:1024
    buffer_load_dwordx4 v[36:39], v4, s[8:11], 0 offen offset:1024
    s_waitcnt vmcnt(10)
    v_mfma_f32_32x32x16_bf16 v[64:79], v[40:43], v[44:47], v[64:79]
    buffer_load_dwordx4 v[40:43], v3, s[4:7], 0 offen offset:2048
    buffer_load_dwordx4 v[44:47], v4, s[8:11], 0 offen offset:2048
    s_waitcnt vmcnt(10)
    v_mfma_f32_32x32x16_bf16 v[64:79], v[48:51], v[52:55], v[64:79]
    buffer_load_dwordx4 v[48:51], v3, s[4:7], 0 offen offset:3072
    buffer_load_dwordx4 v[52:55], v4, s[8:11], 0 offen offset:3072
    v_add_u32 v3, 0x1000, v3
    v_add_u32 v4, 0x1000, v4
    s_waitcnt vmcnt(10)
    v_mfma_f32_32x32x16_bf16 v[64:79], v[8:11], v[12:15], v[64:79]
    buffer_load_dwordx4 v[8:11], v3, s[4:7], 0 offen offset:0
    buffer_load_dwordx4 v[12:15], v4, s[8:11], 0 offen offset:0
    s_waitcnt vmcnt(10)
    v_mfma_f32_32x32x16_bf16 v[64:79], v[16:19], v[20:23], v[64:79]
    buffer_load_dwordx4 v[16:19], v3, s[4:7], 0 offen offset:1024
    buffer_load_dwordx4 v[20:23], v4, s[8:11], 0 offen offset:1024
    s_waitcnt vmcnt(10)
    v_mfma_f32_32x32x16_bf16 v[64:79], v[24:27], v[28:31], v[64:79]
    buffer_load_dwordx4 v[24:27], v3, s[4:7], 0 offen offset:2048
    buffer_load_dwordx4 v[28:31], v4, s[8:11], 0 offen offset:2048
    s_waitcnt vmcnt(10)
    v_mfma_f32_32x32x16_bf16 v[64:79], v[32:35], v[36:39], v[64:79]
    buffer_load_dwordx4 v[32:35], v3, s[4:7], 0 offen offset:3072
    buffer_load_dwordx4 v[36:39], v4, s[8:11], 0 offen offset:3072
    v_add_u32 v3, 0x1000, v3
    v_add_u32 v4, 0x1000, v4
    s_waitcnt vmcnt(10)
    v_mfma_f32_32x32x16_bf16 v[64:79], v[40:43], v[44:47], v[64:79]
    buffer_load_dwordx4 v[40:43], v3, s[4:7], 0 offen offset:0
    buffer_load_dwordx4 v[44:47], v4, s[8:11], 0 offen offset:0
    s_waitcnt vmcnt(10)
    v_mfma_f32_32x32x16_bf16 v[64:79], v[48:51], v[52:55], v[64:79]
    buffer_load_dwordx4 v[48:51], v3, s[4:7], 0 offen offset:1024
    buffer_load_dwordx4 v[52:55], v4, s[8:11], 0 offen offset:1024
    s_waitcnt vmcnt(10)
    v_mfma_f32_32x32x16_bf16 v[64:79], v[8:11], v[12:15], v[64:79]
    buffer_load_dwordx4 v[8:11], v3, s[4:7], 0 offen offset:2048
    buffer_load_dwordx4 v[12:15], v4, s[8:11], 0 offen offset:2048
    s_waitcnt vmcnt(10)
    v_mfma_f32_32x32x16_bf16 v[64:79], v[16:19], v[20:23], v[64:79]
    buffer_load_dwordx4 v[16:19], v3, s[4:7], 0 offen offset:3072
    buffer_load_dwordx4 v[20:23], v4, s[8:11], 0 offen offset:3072
    v_add_u32 v3, 0x1000, v3
    v_add_u32 v4, 0x1000, v4
    s_waitcnt vmcnt(10)
    v_mfma_f32_32x32x16_bf16 v[64:79], v[24:27], v[28:31], v[64:79]
    buffer_load_dwordx4 v[24:27], v3, s[4:7], 0 offen offset:0
    buffer_load_dwordx4 v[28:31], v4, s[8:11], 0 offen offset:0
    s_waitcnt vmcnt(10)
    v_mfma_f32_32x32x16_bf16 v[64:79], v[32:35], v[36:39], v[64:79]
    buffer_load_dwordx4 v[32:35], v3, s[4:7], 0 offen offset:1024
    buffer_load_dwordx4 v[36:39], v4, s[8:11], 0 offen offset:1024
    s_waitcnt vmcnt(10)
    v_mfma_f32_32x32x16_bf16 v[64:79], v[40:43], v[44:47], v[64:79]
    buffer_load_dwordx4 v[40:43], v3, s[4:7], 0 offen offset:2048
    buffer_load_dwordx4 v[44:47], v4, s[8:11], 0 offen offset:2048
    s_waitcnt vmcnt(10)
    v_mfma_f32_32x32x16_bf16 v[64:79], v[48:51], v[52:55], v[64:79]
    buffer_load_dwordx4 v[48:51], v3, s[4:7], 0 offen offset:3072
    buffer_load_dwordx4 v[52:55], v4, s[8:11], 0 offen offset:3072
    v_add_u32 v3, 0x1000, v3
    v_add_u32 v4, 0x1000, v4
    s_waitcnt vmcnt(10)
    v_mfma_f32_32x32x16_bf16 v[64:79], v[8:11], v[12:15], v[64:79]
    buffer_load_dwordx4 v[8:11], v3, s[4:7], 0 offen offset:0
    buffer_load_dwordx4 v[12:15], v4, s[8:11], 0 offen offset:0
    s_waitcnt vmcnt(10)
    v_mfma_f32_32x32x16_bf16 v[64:79], v[16:19], v[20:23], v[64:79]
    buffer_load_dwordx4 v[16:19], v3, s[4:7], 0 offen offset:1024
    buffer_load_dwordx4 v[20:23], v4, s[8:11], 0 offen offset:1024
    s_waitcnt vmcnt(10)
    v_mfma_f32_32x32x16_bf16 v[64:79], v[24:27], v[28:31], v[64:79]
    buffer_load_dwordx4 v[24:27], v3, s[4:7], 0 offen offset:2048
    buffer_load_dwordx4 v[28:31], v4, s[8:11], 0 offen offset:2048
    s_waitcnt vmcnt(10)
    v_mfma_f32_32x32x16_bf16 v[64:79], v[32:35], v[36:39], v[64:79]
    buffer_load_dwordx4 v[32:35], v3, s[4:7], 0 offen offset:3072
    buffer_load_dwordx4 v[36:39], v4, s[8:11], 0 offen offset:3072
    v_add_u32 v3, 0x1000, v3
    v_add_u32 v4, 0x1000, v4
    s_waitcnt vmcnt(10)
    v_mfma_f32_32x32x16_bf16 v[64:79], v[40:43], v[44:47], v[64:79]
    buffer_load_dwordx4 v[40:43], v3, s[4:7], 0 offen offset:0
    buffer_load_dwordx4 v[44:47], v4, s[8:11], 0 offen offset:0
    s_waitcnt vmcnt(10)
    v_mfma_f32_32x32x16_bf16 v[64:79], v[48:51], v[52:55], v[64:79]
    buffer_load_dwordx4 v[48:51], v3, s[4:7], 0 offen offset:1024
    buffer_load_dwordx4 v[52:55], v4, s[8:11], 0 offen offset:1024
    s_waitcnt vmcnt(10)
    v_mfma_f32_32x32x16_bf16 v[64:79], v[8:11], v[12:15], v[64:79]
    buffer_load_dwordx4 v[8:11], v3, s[4:7], 0 offen offset:2048
    buffer_load_dwordx4 v[12:15], v4, s[8:11], 0 offen offset:2048
    s_waitcnt vmcnt(10)
    v_mfma_f32_32x32x16_bf16 v[64:79], v[16:19], v[20:23], v[64:79]
    buffer_load_dwordx4 v[16:19], v3, s[4:7], 0 offen offset:3072
    buffer_load_dwordx4 v[20:23], v4, s[8:11], 0 offen offset:3072
    v_add_u32 v3, 0x1000, v3
    v_add_u32 v4, 0x1000, v4
    s_waitcnt vmcnt(10)
    v_mfma_f32_32x32x16_bf16 v[64:79], v[24:27], v[28:31], v[64:79]
    buffer_load_dwordx4 v[24:27], v3, s[4:7], 0 offen offset:0
    buffer_load_dwordx4 v[28:31], v4, s[8:11], 0 offen offset:0
    s_waitcnt vmcnt(10)
    v_mfma_f32_32x32x16_bf16 v[64:79], v[32:35], v[36:39], v[64:79]
    buffer_load_dwordx4 v[32:35], v3, s[4:7], 0 offen offset:1024
    buffer_load_dwordx4 v[36:39], v4, s[8:11], 0 offen offset:1024
    s_waitcnt vmcnt(10)
    v_mfma_f32_32x32x16_bf16 v[64:79], v[40:43], v[44:47], v[64:79]
    buffer_load_dwordx4 v[40:43], v3, s[4:7], 0 offen offset:2048
    buffer_load_dwordx4 v[44:47], v4, s[8:11], 0 offen offset:2048
    s_waitcnt vmcnt(10)
    v_mfma_f32_32x32x16_bf16 v[64:79], v[48:51], v[52:55], v[64:79]
    buffer_load_dwordx4 v[48:51], v3, s[4:7], 0 offen offset:3072
    buffer_load_dwordx4 v[52:55], v4, s[8:11], 0 offen offset:3072
    v_add_u32 v3, 0x1000, v3
    v_add_u32 v4, 0x1000, v4
    s_waitcnt vmcnt(10)
    v_mfma_f32_32x32x16_bf16 v[64:79], v[8:11], v[12:15], v[64:79]
    buffer_load_dwordx4 v[8:11], v3, s[4:7], 0 offen offset:0
    buffer_load_dwordx4 v[12:15], v4, s[8:11], 0 offen offset:0
    s_waitcnt vmcnt(10)
    v_mfma_f32_32x32x16_bf16 v[64:79], v[16:19], v[20:23], v[64:79]
    buffer_load_dwordx4 v[16:19], v3, s[4:7], 0 offen offset:1024
    buffer_load_dwordx4 v[20:23], v4, s[8:11], 0 offen offset:1024
    s_waitcnt vmcnt(10)
    v_mfma_f32_32x32x16_bf16 v[64:79], v[24:27], v[28:31], v[64:79]
    buffer_load_dwordx4 v[24:27], v3, s[4:7], 0 offen offset:2048
    buffer_load_dwordx4 v[28:31], v4, s[8:11], 0 offen offset:2048
    s_waitcnt vmcnt(10)
    v_mfma_f32_32x32x16_bf16 v[64:79], v[32:35], v[36:39], v[64:79]
    buffer_load_dwordx4 v[32:35], v3, s[4:7], 0 offen offset:3072
    buffer_load_dwordx4 v[36:39], v4, s[8:11], 0 offen offset:3072
    v_add_u32 v3, 0x1000, v3
    v_add_u32 v4, 0x1000, v4
    s_waitcnt vmcnt(10)
    v_mfma_f32_32x32x16_bf16 v[64:79], v[40:43], v[44:47], v[64:79]
    buffer_load_dwordx4 v[40:43], v3, s[4:7], 0 offen offset:0
    buffer_load_dwordx4 v[44:47], v4, s[8:11], 0 offen offset:0
    s_waitcnt vmcnt(10)
    v_mfma_f32_32x32x16_bf16 v[64:79], v[48:51], v[52:55], v[64:79]
    buffer_load_dwordx4 v[48:51], v3, s[4:7], 0 offen offset:1024
    buffer_load_dwordx4 v[52:55], v4, s[8:11], 0 offen offset:1024
    s_waitcnt vmcnt(10)
    v_mfma_f32_32x32x16_bf16 v[64:79], v[8:11], v[12:15], v[64:79]
    buffer_load_dwordx4 v[8:11], v3, s[4:7], 0 offen offset:2048
    buffer_load_dwordx4 v[12:15], v4, s[8:11], 0 offen offset:2048
    s_waitcnt vmcnt(10)
    v_mfma_f32_32x32x16_bf16 v[64:79], v[16:19], v[20:23], v[64:79]
    buffer_load_dwordx4 v[16:19], v3, s[4:7], 0 offen offset:3072
    buffer_load_dwordx4 v[20:23], v4, s[8:11], 0 offen offset:3072
    v_add_u32 v3, 0x1000, v3
    v_add_u32 v4, 0x1000, v4
    s_waitcnt vmcnt(10)
    v_mfma_f32_32x32x16_bf16 v[64:79], v[24:27], v[28:31], v[64:79]
    buffer_load_dwordx4 v[24:27], v3, s[4:7], 0 offen offset:0
    buffer_load_dwordx4 v[28:31], v4, s[8:11], 0 offen offset:0
    s_waitcnt vmcnt(10)
    v_mfma_f32_32x32x16_bf16 v[64:79], v[32:35], v[36:39], v[64:79]
    buffer_load_dwordx4 v[32:35], v3, s[4:7], 0 offen offset:1024
    buffer_load_dwordx4 v[36:39], v4, s[8:11], 0 offen offset:1024
    s_waitcnt vmcnt(10)
    v_mfma_f32_32x32x16_bf16 v[64:79], v[40:43], v[44:47], v[64:79]
    buffer_load_dwordx4 v[40:43], v3, s[4:7], 0 offen offset:2048
    buffer_load_dwordx4 v[44:47], v4, s[8:11], 0 offen offset:2048
    s_waitcnt vmcnt(10)
    v_mfma_f32_32x32x16_bf16 v[64:79], v[48:51], v[52:55], v[64:79]
    buffer_load_dwordx4 v[48:51], v3, s[4:7], 0 offen offset:3072
    buffer_load_dwordx4 v[52:55], v4, s[8:11], 0 offen offset:3072
    v_add_u32 v3, 0x1000, v3
    v_add_u32 v4, 0x1000, v4
    s_waitcnt vmcnt(10)
    v_mfma_f32_32x32x16_bf16 v[64:79], v[8:11], v[12:15], v[64:79]
    buffer_load_dwordx4 v[8:11], v3, s[4:7], 0 offen offset:0
    buffer_load_dwordx4 v[12:15], v4, s[8:11], 0 offen offset:0
    s_waitcnt vmcnt(10)
    v_mfma_f32_32x32x16_bf16 v[64:79], v[16:19], v[20:23], v[64:79]
    buffer_load_dwordx4 v[16:19], v3, s[4:7], 0 offen offset:1024
    buffer_load_dwordx4 v[20:23], v4, s[8:11], 0 offen offset:1024
    s_waitcnt vmcnt(10)
    v_mfma_f32_32x32x16_bf16 v[64:79], v[24:27], v[28:31], v[64:79]
    buffer_load_dwordx4 v[24:27], v3, s[4:7], 0 offen offset:2048
    buffer_load_dwordx4 v[28:31], v4, s[8:11], 0 offen offset:2048
    s_waitcnt vmcnt(10)
    v_mfma_f32_32x32x16_bf16 v[64:79], v[32:35], v[36:39], v[64:79]
    buffer_load_dwordx4 v[32:35], v3, s[4:7], 0 offen offset:3072
    buffer_load_dwordx4 v[36:39], v4, s[8:11], 0 offen offset:3072
    v_add_u32 v3, 0x1000, v3
    v_add_u32 v4, 0x1000, v4
    s_waitcnt vmcnt(10)
    v_mfma_f32_32x32x16_bf16 v[64:79], v[40:43], v[44:47], v[64:79]
    buffer_load_dwordx4 v[40:43], v3, s[4:7], 0 offen offset:0
    buffer_load_dwordx4 v[44:47], v4, s[8:11], 0 offen offset:0
    s_waitcnt vmcnt(10)
    v_mfma_f32_32x32x16_bf16 v[64:79], v[48:51], v[52:55], v[64:79]
    buffer_load_dwordx4 v[48:51], v3, s[4:7], 0 offen offset:1024
    buffer_load_dwordx4 v[52:55], v4, s[8:11], 0 offen offset:1024
    s_waitcnt vmcnt(10)
    v_mfma_f32_32x32x16_bf16 v[64:79], v[8:11], v[12:15], v[64:79]
    buffer_load_dwordx4 v[8:11], v3, s[4:7], 0 offen offset:2048
    buffer_load_dwordx4 v[12:15], v4, s[8:11], 0 offen offset:2048
    s_waitcnt vmcnt(10)
    v_mfma_f32_32x32x16_bf16 v[64:79], v[16:19], v[20:23], v[64:79]
    buffer_load_dwordx4 v[16:19], v3, s[4:7], 0 offen offset:3072
    buffer_load_dwordx4 v[20:23], v4, s[8:11], 0 offen offset:3072
    v_add_u32 v3, 0x1000, v3
    v_add_u32 v4, 0x1000, v4
    s_waitcnt vmcnt(10)
    v_mfma_f32_32x32x16_bf16 v[64:79], v[24:27], v[28:31], v[64:79]
    buffer_load_dwordx4 v[24:27], v3, s[4:7], 0 offen offset:0
    buffer_load_dwordx4 v[28:31], v4, s[8:11], 0 offen offset:0
    s_waitcnt vmcnt(10)
    v_mfma_f32_32x32x16_bf16 v[64:79], v[32:35], v[36:39], v[64:79]
    buffer_load_dwordx4 v[32:35], v3, s[4:7], 0 offen offset:1024
    buffer_load_dwordx4 v[36:39], v4, s[8:11], 0 offen offset:1024
    s_waitcnt vmcnt(10)
    v_mfma_f32_32x32x16_bf16 v[64:79], v[40:43], v[44:47], v[64:79]
    buffer_load_dwordx4 v[40:43], v3, s[4:7], 0 offen offset:2048
    buffer_load_dwordx4 v[44:47], v4, s[8:11], 0 offen offset:2048
    s_waitcnt vmcnt(10)
    v_mfma_f32_32x32x16_bf16 v[64:79], v[48:51], v[52:55], v[64:79]
    buffer_load_dwordx4 v[48:51], v3, s[4:7], 0 offen offset:3072
    buffer_load_dwordx4 v[52:55], v4, s[8:11], 0 offen offset:3072
    v_add_u32 v3, 0x1000, v3
    v_add_u32 v4, 0x1000, v4
    s_waitcnt vmcnt(10)
    v_mfma_f32_32x32x16_bf16 v[64:79], v[8:11], v[12:15], v[64:79]
    buffer_load_dwordx4 v[8:11], v3, s[4:7], 0 offen offset:0
    buffer_load_dwordx4 v[12:15], v4, s[8:11], 0 offen offset:0
    s_waitcnt vmcnt(10)
    v_mfma_f32_32x32x16_bf16 v[64:79], v[16:19], v[20:23], v[64:79]
    buffer_load_dwordx4 v[16:19], v3, s[4:7], 0 offen offset:1024
    buffer_load_dwordx4 v[20:23], v4, s[8:11], 0 offen offset:1024
    s_waitcnt vmcnt(10)
    v_mfma_f32_32x32x16_bf16 v[64:79], v[24:27], v[28:31], v[64:79]
    buffer_load_dwordx4 v[24:27], v3, s[4:7], 0 offen offset:2048
    buffer_load_dwordx4 v[28:31], v4, s[8:11], 0 offen offset:2048
    s_waitcnt vmcnt(10)
    v_mfma_f32_32x32x16_bf16 v[64:79], v[32:35], v[36:39], v[64:79]
    buffer_load_dwordx4 v[32:35], v3, s[4:7], 0 offen offset:3072
    buffer_load_dwordx4 v[36:39], v4, s[8:11], 0 offen offset:3072
    v_add_u32 v3, 0x1000, v3
    v_add_u32 v4, 0x1000, v4
    s_waitcnt vmcnt(10)
    v_mfma_f32_32x32x16_bf16 v[64:79], v[40:43], v[44:47], v[64:79]
    buffer_load_dwordx4 v[40:43], v3, s[4:7], 0 offen offset:0
    buffer_load_dwordx4 v[44:47], v4, s[8:11], 0 offen offset:0
    s_waitcnt vmcnt(10)
    v_mfma_f32_32x32x16_bf16 v[64:79], v[48:51], v[52:55], v[64:79]
    buffer_load_dwordx4 v[48:51], v3, s[4:7], 0 offen offset:1024
    buffer_load_dwordx4 v[52:55], v4, s[8:11], 0 offen offset:1024
    s_waitcnt vmcnt(10)
    v_mfma_f32_32x32x16_bf16 v[64:79], v[8:11], v[12:15], v[64:79]
    buffer_load_dwordx4 v[8:11], v3, s[4:7], 0 offen offset:2048
    buffer_load_dwordx4 v[12:15], v4, s[8:11], 0 offen offset:2048
    s_waitcnt vmcnt(10)
    v_mfma_f32_32x32x16_bf16 v[64:79], v[16:19], v[20:23], v[64:79]
    buffer_load_dwordx4 v[16:19], v3, s[4:7], 0 offen offset:3072
    buffer_load_dwordx4 v[20:23], v4, s[8:11], 0 offen offset:3072
    v_add_u32 v3, 0x1000, v3
    v_add_u32 v4, 0x1000, v4
    s_waitcnt vmcnt(10)
    v_mfma_f32_32x32x16_bf16 v[64:79], v[24:27], v[28:31], v[64:79]
    buffer_load_dwordx4 v[24:27], v3, s[4:7], 0 offen offset:0
    buffer_load_dwordx4 v[28:31], v4, s[8:11], 0 offen offset:0
    s_waitcnt vmcnt(10)
    v_mfma_f32_32x32x16_bf16 v[64:79], v[32:35], v[36:39], v[64:79]
    buffer_load_dwordx4 v[32:35], v3, s[4:7], 0 offen offset:1024
    buffer_load_dwordx4 v[36:39], v4, s[8:11], 0 offen offset:1024
    s_waitcnt vmcnt(10)
    v_mfma_f32_32x32x16_bf16 v[64:79], v[40:43], v[44:47], v[64:79]
    buffer_load_dwordx4 v[40:43], v3, s[4:7], 0 offen offset:2048
    buffer_load_dwordx4 v[44:47], v4, s[8:11], 0 offen offset:2048
    s_waitcnt vmcnt(10)
    v_mfma_f32_32x32x16_bf16 v[64:79], v[48:51], v[52:55], v[64:79]
    buffer_load_dwordx4 v[48:51], v3, s[4:7], 0 offen offset:3072
    buffer_load_dwordx4 v[52:55], v4, s[8:11], 0 offen offset:3072
    v_add_u32 v3, 0x1000, v3
    v_add_u32 v4, 0x1000, v4
    s_waitcnt vmcnt(10)
    v_mfma_f32_32x32x16_bf16 v[64:79], v[8:11], v[12:15], v[64:79]
    buffer_load_dwordx4 v[8:11], v3, s[4:7], 0 offen offset:0
    buffer_load_dwordx4 v[12:15], v4, s[8:11], 0 offen offset:0
    s_waitcnt vmcnt(10)
    v_mfma_f32_32x32x16_bf16 v[64:79], v[16:19], v[20:23], v[64:79]
    buffer_load_dwordx4 v[16:19], v3, s[4:7], 0 offen offset:1024
    buffer_load_dwordx4 v[20:23], v4, s[8:11], 0 offen offset:1024
    s_waitcnt vmcnt(10)
    v_mfma_f32_32x32x16_bf16 v[64:79], v[24:27], v[28:31], v[64:79]
    s_waitcnt vmcnt(8)
    v_mfma_f32_32x32x16_bf16 v[64:79], v[32:35], v[36:39], v[64:79]
    s_waitcnt vmcnt(6)
    v_mfma_f32_32x32x16_bf16 v[64:79], v[40:43], v[44:47], v[64:79]
    s_waitcnt vmcnt(4)
    v_mfma_f32_32x32x16_bf16 v[64:79], v[48:51], v[52:55], v[64:79]
    s_waitcnt vmcnt(2)
    v_mfma_f32_32x32x16_bf16 v[64:79], v[8:11], v[12:15], v[64:79]
    s_waitcnt vmcnt(0)
    v_mfma_f32_32x32x16_bf16 v[64:79], v[16:19], v[20:23], v[64:79]
    v_and_b32 v6, 31, v1
    s_lshl_b32 s64, s60, 5
    v_add_u32 v6, s64, v6
    v_lshlrev_b32 v6, 10, v6
    v_lshrrev_b32 v7, 5, v1
    v_lshl_add_u32 v6, v7, 3, v6
    s_lshl_b32 s64, s61, 6
    v_add_u32 v6, s64, v6
    buffer_load_dwordx2 v[8:9], v6, s[12:15], 0 offen offset:0
    buffer_load_dwordx2 v[10:11], v6, s[12:15], 0 offen offset:16
    buffer_load_dwordx2 v[12:13], v6, s[12:15], 0 offen offset:32
    buffer_load_dwordx2 v[14:15], v6, s[12:15], 0 offen offset:48
    s_nop 15
    s_waitcnt vmcnt(0)
    v_cvt_pk_bf16_f32 v20, v64, v65
    v_lshlrev_b32 v21, 16, v20
    v_and_b32 v22, 0xffff0000, v20
    v_lshlrev_b32 v23, 16, v8
    v_and_b32 v24, 0xffff0000, v8
    v_add_f32 v21, v21, v23
    v_add_f32 v22, v22, v24
    v_cvt_pk_bf16_f32 v26, v21, v22
    v_cvt_pk_bf16_f32 v20, v66, v67
    v_lshlrev_b32 v21, 16, v20
    v_and_b32 v22, 0xffff0000, v20
    v_lshlrev_b32 v23, 16, v9
    v_and_b32 v24, 0xffff0000, v9
    v_add_f32 v21, v21, v23
    v_add_f32 v22, v22, v24
    v_cvt_pk_bf16_f32 v27, v21, v22
    buffer_store_dwordx2 v[26:27], v6, s[16:19], 0 offen offset:0
    s_nop 1
    v_cvt_pk_bf16_f32 v20, v68, v69
    v_lshlrev_b32 v21, 16, v20
    v_and_b32 v22, 0xffff0000, v20
    v_lshlrev_b32 v23, 16, v10
    v_and_b32 v24, 0xffff0000, v10
    v_add_f32 v21, v21, v23
    v_add_f32 v22, v22, v24
    v_cvt_pk_bf16_f32 v26, v21, v22
    v_cvt_pk_bf16_f32 v20, v70, v71
    v_lshlrev_b32 v21, 16, v20
    v_and_b32 v22, 0xffff0000, v20
    v_lshlrev_b32 v23, 16, v11
    v_and_b32 v24, 0xffff0000, v11
    v_add_f32 v21, v21, v23
    v_add_f32 v22, v22, v24
    v_cvt_pk_bf16_f32 v27, v21, v22
    buffer_store_dwordx2 v[26:27], v6, s[16:19], 0 offen offset:16
    s_nop 1
    v_cvt_pk_bf16_f32 v20, v72, v73
    v_lshlrev_b32 v21, 16, v20
    v_and_b32 v22, 0xffff0000, v20
    v_lshlrev_b32 v23, 16, v12
    v_and_b32 v24, 0xffff0000, v12
    v_add_f32 v21, v21, v23
    v_add_f32 v22, v22, v24
    v_cvt_pk_bf16_f32 v26, v21, v22
    v_cvt_pk_bf16_f32 v20, v74, v75
    v_lshlrev_b32 v21, 16, v20
    v_and_b32 v22, 0xffff0000, v20
    v_lshlrev_b32 v23, 16, v13
    v_and_b32 v24, 0xffff0000, v13
    v_add_f32 v21, v21, v23
    v_add_f32 v22, v22, v24
    v_cvt_pk_bf16_f32 v27, v21, v22
    buffer_store_dwordx2 v[26:27], v6, s[16:19], 0 offen offset:32
    s_nop 1
    v_cvt_pk_bf16_f32 v20, v76, v77
    v_lshlrev_b32 v21, 16, v20
    v_and_b32 v22, 0xffff0000, v20
    v_lshlrev_b32 v23, 16, v14
    v_and_b32 v24, 0xffff0000, v14
    v_add_f32 v21, v21, v23
    v_add_f32 v22, v22, v24
    v_cvt_pk_bf16_f32 v26, v21, v22
    v_cvt_pk_bf16_f32 v20, v78, v79
    v_lshlrev_b32 v21, 16, v20
    v_and_b32 v22, 0xffff0000, v20
    v_lshlrev_b32 v23, 16, v15
    v_and_b32 v24, 0xffff0000, v15
    v_add_f32 v21, v21, v23
    v_add_f32 v22, v22, v24
    v_cvt_pk_bf16_f32 v27, v21, v22
    buffer_store_dwordx2 v[26:27], v6, s[16:19], 0 offen offset:48
    s_nop 1
L_g2b_kernel_end:
    s_endpgm
.section .rodata,"a"
.p2align 6
.amdhsa_kernel conv_kernel
  .amdhsa_next_free_vgpr 128
  .amdhsa_next_free_sgpr 96
  .amdhsa_accum_offset 128
  .amdhsa_group_segment_fixed_size 0
  .amdhsa_kernarg_size 104
  .amdhsa_user_sgpr_count 2
  .amdhsa_user_sgpr_kernarg_segment_ptr 1
  .amdhsa_system_sgpr_workgroup_id_x 1
.end_amdhsa_kernel
.p2align 6
.amdhsa_kernel ln1_kernel
  .amdhsa_next_free_vgpr 128
  .amdhsa_next_free_sgpr 96
  .amdhsa_accum_offset 128
  .amdhsa_group_segment_fixed_size 0
  .amdhsa_kernarg_size 104
  .amdhsa_user_sgpr_count 2
  .amdhsa_user_sgpr_kernarg_segment_ptr 1
  .amdhsa_system_sgpr_workgroup_id_x 1
.end_amdhsa_kernel
.p2align 6
.amdhsa_kernel ln2_kernel
  .amdhsa_next_free_vgpr 128
  .amdhsa_next_free_sgpr 96
  .amdhsa_accum_offset 128
  .amdhsa_group_segment_fixed_size 0
  .amdhsa_kernarg_size 104
  .amdhsa_user_sgpr_count 2
  .amdhsa_user_sgpr_kernarg_segment_ptr 1
  .amdhsa_system_sgpr_workgroup_id_x 1
.end_amdhsa_kernel
.p2align 6
.amdhsa_kernel g1_kernel
  .amdhsa_next_free_vgpr 128
  .amdhsa_next_free_sgpr 96
  .amdhsa_accum_offset 128
  .amdhsa_group_segment_fixed_size 0
  .amdhsa_kernarg_size 104
  .amdhsa_user_sgpr_count 2
  .amdhsa_user_sgpr_kernarg_segment_ptr 1
  .amdhsa_system_sgpr_workgroup_id_x 1
.end_amdhsa_kernel
.p2align 6
.amdhsa_kernel g2a_kernel
  .amdhsa_next_free_vgpr 80
  .amdhsa_next_free_sgpr 96
  .amdhsa_accum_offset 80
  .amdhsa_group_segment_fixed_size 0
  .amdhsa_kernarg_size 104
  .amdhsa_user_sgpr_count 2
  .amdhsa_user_sgpr_kernarg_segment_ptr 1
  .amdhsa_system_sgpr_workgroup_id_x 1
.end_amdhsa_kernel
.p2align 6
.amdhsa_kernel g2b_kernel
  .amdhsa_next_free_vgpr 80
  .amdhsa_next_free_sgpr 96
  .amdhsa_accum_offset 80
  .amdhsa_group_segment_fixed_size 0
  .amdhsa_kernarg_size 104
  .amdhsa_user_sgpr_count 2
  .amdhsa_user_sgpr_kernarg_segment_ptr 1
  .amdhsa_system_sgpr_workgroup_id_x 1
.end_amdhsa_kernel
```
